```python
import torch

def _softmax(x, axis=-1):
    return torch.softmax(x, dim=axis)
def _gelu(x):
    return torch.nn.functional.gelu(x, approximate="tanh")
def _silu(x):
    return torch.nn.functional.silu(x)
def _sigmoid(x):
    return torch.sigmoid(x)
def _layernorm(x, axis=-1, eps=1e-5):
    m = x.mean(dim=axis, keepdim=True)
    v = x.var(dim=axis, keepdim=True, unbiased=False)
    return (x - m) / torch.sqrt(v + eps)
def _scatter_add(tgt, idx, src, axis=0):
    return tgt.clone().index_add_(axis, idx, src)
def _segment_sum(src, seg, n):
    out = torch.zeros((n,) + src.shape[1:], dtype=src.dtype)
    return out.index_add_(0, seg, src)
def _pad(x, pw):
    flat = tuple(v for pair in reversed(pw) for v in pair)
    return torch.nn.functional.pad(x, flat)

kernel_name = 'gated_mix__sliding_block__linear_attn_block__prompt'

def setup_inputs():

    _w = (lambda a: (lambda t: t.to(torch.bfloat16) if t.is_floating_point() else t)(torch.as_tensor(a)))
    def _A_setup():
        B, S, D = 1, 2048, 640
        return {
            "x": _w((lambda *s: torch.randn(*s, dtype=torch.bfloat16) * 0.05)(B, S, D)),
            "wqkv": _w((lambda *s: torch.randn(*s, dtype=torch.bfloat16) * 0.8)(D, 3 * D)),
            "wo": _w((lambda *s: torch.randn(*s, dtype=torch.bfloat16) * 0.05)(D, D)),
        }
    _A_in = _A_setup()

    def _B_setup():
        B, S, D = 1, 2048, 640
        return {
            "x": _w((lambda *s: torch.randn(*s, dtype=torch.bfloat16) * 0.05)(B, S, D)),
            "wqkv": _w((lambda *s: torch.randn(*s, dtype=torch.bfloat16) * 1.6)(D, 3 * D)),
            "wo": _w((lambda *s: torch.randn(*s, dtype=torch.bfloat16) * 0.4)(D, D)),
        }
    _B_in = _B_setup()

    return {
        "A_x": _A_in["x"],
        "A_wqkv": _A_in["wqkv"],
        "A_wo": _A_in["wo"],
        "B_x": _B_in["x"],
        "B_wqkv": _B_in["wqkv"],
        "B_wo": _B_in["wo"],
        "gate_w": _w((lambda *s: torch.randn(*s, dtype=torch.bfloat16) * 0.05)(640) * 16.0),
    }

def reference(A_x, A_wqkv, A_wo, B_x, B_wqkv, B_wo, gate_w):
    def _A_ref(x, wqkv, wo):
        B, S, D = x.shape
        H = 32; Dh = D // H; W = 256
        qkv = (lambda x, *d: x.permute(*d))((x @ wqkv).reshape(B, S, 3, H, Dh), 2, 0, 3, 1, 4)
        q, k, v = qkv[0], qkv[1], qkv[2]
        scores = torch.einsum("bhqd,bhkd->bhqk", q, k) * (Dh ** -0.5)
        idx = torch.arange(S)
        mask = (idx[:, None] - idx[None, :] >= 0) & (idx[:, None] - idx[None, :] < W)
        scores = torch.where(mask[None, None], scores, -1e9)
        p = _softmax(scores, axis=-1)
        o = torch.einsum("bhqk,bhkd->bhqd", p, v)
        return (lambda x, *d: x.permute(*d))(o, 0, 2, 1, 3).reshape(B, S, D) @ wo

    def _B_ref(x, wqkv, wo):
        B, S, D = x.shape
        H = 32; Dh = D // H
        qkv = (lambda x, *d: x.permute(*d))((x @ wqkv).reshape(B, S, 3, H, Dh), 2, 0, 3, 1, 4)
        q, k, v = qkv[0], qkv[1], qkv[2]
        phi = lambda t: torch.where(t > 0, t + 1, torch.exp(t)) + 1e-6
        pq, pk = phi(q), phi(k)
        kv = torch.einsum("bhsd,bhse->bhde", pk, v)
        z = torch.einsum("bhsd->bhd", pk)
        num = torch.einsum("bhqd,bhde->bhqe", pq, kv)
        den = torch.einsum("bhqd,bhd->bhq", pq, z)[..., None] + 1e-6
        o = num / den
        return (lambda x, *d: x.permute(*d))(o, 0, 2, 1, 3).reshape(B, S, D) @ wo

    x = A_x
    g = _sigmoid((x * gate_w).sum(-1, keepdims=True))
    a = _A_ref(x, A_wqkv, A_wo)
    b = _B_ref(x, B_wqkv, B_wo)
    return g * a + (1 - g) * b
```

```asm
; @launch grid=(256,1,1) block=(512,1,1) lds=163840
.amdgcn_target "amdgcn-amd-amdhsa--gfx950"
.text
.globl gated_mix__sliding_block__linear_attn_block__prompt_kernel
.p2align 8
.type gated_mix__sliding_block__linear_attn_block__prompt_kernel,@function
gated_mix__sliding_block__linear_attn_block__prompt_kernel:
    s_cmp_ge_u32 s2, 256
    s_cbranch_scc1 K1_end
    s_load_dwordx4 s[4:7], s[0:1], 0
    s_load_dwordx2 s[8:9], s[0:1], 32
    s_load_dwordx2 s[10:11], s[0:1], 72
    s_load_dwordx2 s[76:77], s[0:1], 16
    s_load_dwordx4 s[80:83], s[0:1], 40
    s_load_dwordx2 s[96:97], s[0:1], 64
    v_lshrrev_b32 v1, 6, v0
    v_and_b32 v2, 63, v0
    v_readfirstlane_b32 s33, v1
    s_and_b32 s34, s2, 7
    s_lshr_b32 s35, s2, 3
    s_lshr_b32 s36, s34, 2
    s_and_b32 s37, s34, 3
    s_lshr_b32 s58, s35, 2
    s_and_b32 s59, s35, 3
    s_lshl_b32 s24, s36, 3
    s_add_u32 s24, s24, s58
    s_lshr_b32 s26, s59, 1
    s_and_b32 s25, s59, 1
    s_lshl_b32 s40, s37, 1
    s_add_u32 s25, s25, s40
    s_lshl_b32 s43, s37, 2
    s_add_u32 s43, s43, s59
    v_lshrrev_b32 v3, 3, v2
    v_and_b32 v10, 7, v2
    v_xor_b32 v10, v10, v3
    v_lshlrev_b32 v10, 4, v10
    s_movk_i32 s40, 1280
    v_mad_u32_u24 v4, v3, s40, v10
    s_lshl_b32 s34, s24, 7
    s_lshl_b32 s35, s33, 4
    s_add_u32 s34, s34, s35
    s_mul_i32 s34, s34, 1280
    v_add_u32 v4, s34, v4
    v_add_u32 v5, 9216, v4
    v_lshrrev_b32 v3, 5, v2
    v_bfe_u32 v10, v2, 1, 4
    v_and_b32 v11, 1, v2
    v_lshlrev_b32 v11, 4, v11
    s_movk_i32 s35, 3840
    v_mad_u32_u24 v11, v3, s35, v11
    s_and_b32 s36, s33, 1
    s_lshl_b32 s36, s36, 2
    s_mul_i32 s37, s33, 30720
    s_cmp_eq_u32 s26, 0
    s_movk_i32 s39, 160
    s_cselect_b32 s38, 480, s39
    s_cselect_b32 s39, s39, s40
    s_mul_i32 s38, s25, s38
    s_add_u32 s37, s37, s38
    v_mov_b32 v16, 0x40000000
    v_or_b32 v12, s36, v3
    v_xor_b32 v12, v12, v10
    v_mul_u32_u24 v13, 52, v12
    v_lshrrev_b32 v13, 8, v13
    v_mul_u32_u24 v14, 5, v13
    v_sub_u32 v14, v12, v14
    v_lshl_add_u32 v14, v14, 5, v11
    v_mad_u32_u24 v14, v13, s39, v14
    v_add_u32 v14, s37, v14
    v_cmp_eq_u32 vcc, 15, v12
    s_nop 1
    v_cndmask_b32 v6, v14, v16, vcc
    v_add_u32 v8, 13312, v6
    v_or_b32 v12, s36, v3
    v_or_b32 v12, 2, v12
    v_xor_b32 v12, v12, v10
    v_mul_u32_u24 v13, 52, v12
    v_lshrrev_b32 v13, 8, v13
    v_mul_u32_u24 v14, 5, v13
    v_sub_u32 v14, v12, v14
    v_lshl_add_u32 v14, v14, 5, v11
    v_mad_u32_u24 v14, v13, s39, v14
    v_add_u32 v14, s37, v14
    v_add_u32 v14, 6656, v14
    v_cmp_eq_u32 vcc, 15, v12
    s_nop 1
    v_cndmask_b32 v7, v14, v16, vcc
    v_add_u32 v9, 13312, v7
    s_lshl_b32 s56, s33, 11
    s_lshl_b32 s57, s33, 12
    s_add_u32 s57, s57, 16384
    s_add_u32 s34, s58, s59
    s_mul_i32 s35, s34, 86
    s_lshr_b32 s35, s35, 8
    s_mul_i32 s35, s35, 3
    s_sub_u32 s34, s34, s35
    s_mul_i32 s34, s34, 10
    s_mul_i32 s34, s34, 86
    s_lshr_b32 s28, s34, 8
    s_lshl_b32 s29, s28, 7
    s_mul_i32 s30, s28, 245760
    s_mov_b32 m0, s56
    s_waitcnt lgkmcnt(0)
    s_mov_b32 s12, s4
    s_and_b32 s13, s5, 0xffff
    s_mov_b32 s14, 2621440
    s_mov_b32 s15, 0x20000
    s_cmp_eq_u32 s26, 0
    s_cselect_b32 s6, s6, s8
    s_cselect_b32 s7, s7, s9
    s_mov_b32 s16, s6
    s_and_b32 s17, s7, 0xffff
    s_mov_b32 s18, 2457600
    s_mov_b32 s19, 0x20000
    buffer_load_dwordx4 v4, s[12:15], s29 offen lds
    buffer_load_dwordx4 v5, s[12:15], s29 offen offset:1024 lds
    s_add_u32 m0, s57, 0
    s_add_u32 s29, s29, 128
    buffer_load_dwordx4 v6, s[16:19], s30 offen lds
    buffer_load_dwordx4 v7, s[16:19], s30 offen offset:1024 lds
    buffer_load_dwordx4 v8, s[16:19], s30 offen offset:2048 lds
    buffer_load_dwordx4 v9, s[16:19], s30 offen offset:3072 lds
    s_add_u32 s30, s30, 245760
    s_add_u32 s28, s28, 1
    s_cmp_eq_u32 s28, 10
    s_cselect_b32 s29, 0, s29
    s_cselect_b32 s30, 0, s30
    s_mov_b32 s20, s10
    s_and_b32 s21, s11, 0xffff
    s_mov_b32 s22, 23068672
    s_mov_b32 s23, 0x20000
    s_getpc_b64 s[60:61]
K1_pc:
    s_lshl_b32 s34, s33, 13
    v_lshlrev_b32 v26, 7, v2
    v_add_u32 v26, s34, v26
    v_min_u32 v26, CODE_END-K1_pc-4, v26
    global_load_dword v31, v26, s[60:61]
    s_or_b32 s34, s2, s33
    s_cmp_lg_u32 s34, 0
    s_cbranch_scc1 P1_notag
    s_memrealtime s[94:95]
    v_mov_b32 v30, 0
    s_waitcnt lgkmcnt(0)
    s_or_b32 s94, s94, 1
    v_mov_b32 v1, s94
    s_mov_b32 exec_lo, 1
    s_mov_b32 exec_hi, 0
        global_store_dword v30, v1, s[96:97] sc1
    s_mov_b32 exec_lo, -1
    s_mov_b32 exec_hi, -1
P1_notag:
    s_lshr_b32 s41, s33, 2
    s_and_b32 s42, s33, 3
    v_lshrrev_b32 v28, 4, v2
    v_and_b32 v29, 15, v2
    v_and_b32 v3, 7, v2
    v_xor_b32 v3, v3, v28
    v_lshlrev_b32 v3, 4, v3
    v_lshl_add_u32 v3, v29, 7, v3
    s_lshl_b32 s34, s41, 13
    v_add_u32 v10, s34, v3
    v_xor_b32 v11, 64, v10
    v_bfe_u32 v3, v2, 2, 2
    v_and_b32 v1, 1, v28
    v_lshl_or_b32 v1, v1, 2, v3
    v_lshl_add_u32 v30, v28, 3, v3
    v_lshlrev_b32 v30, 9, v30
    v_and_b32 v3, 3, v2
    v_lshl_add_u32 v30, v3, 3, v30
    v_add_u32 v30, 16384, v30
    s_add_u32 s35, s42, 0
    v_xor_b32 v3, s35, v1
    v_lshl_add_u32 v16, v3, 5, v30
    s_sub_u32 s36, s35, 5
    s_cmp_lt_u32 s36, 5
    s_cselect_b32 s52, s26, 0
    s_mul_i32 s44, s52, 0x358637bd
    s_mul_i32 s36, s25, 15
    s_add_u32 s36, s36, s35
    s_cmp_lt_u32 s36, 40
    s_cselect_b32 s36, 1, 0
    s_andn2_b32 s48, s36, s26
    s_add_u32 s35, s42, 4
    v_xor_b32 v3, s35, v1
    v_lshl_add_u32 v17, v3, 5, v30
    s_sub_u32 s36, s35, 5
    s_cmp_lt_u32 s36, 5
    s_cselect_b32 s53, s26, 0
    s_mul_i32 s45, s53, 0x358637bd
    s_mul_i32 s36, s25, 15
    s_add_u32 s36, s36, s35
    s_cmp_lt_u32 s36, 40
    s_cselect_b32 s36, 1, 0
    s_andn2_b32 s49, s36, s26
    s_add_u32 s35, s42, 8
    v_xor_b32 v3, s35, v1
    v_lshl_add_u32 v18, v3, 5, v30
    s_sub_u32 s36, s35, 5
    s_cmp_lt_u32 s36, 5
    s_cselect_b32 s54, s26, 0
    s_mul_i32 s46, s54, 0x358637bd
    s_mul_i32 s36, s25, 15
    s_add_u32 s36, s36, s35
    s_cmp_lt_u32 s36, 40
    s_cselect_b32 s36, 1, 0
    s_andn2_b32 s50, s36, s26
    s_add_u32 s35, s42, 12
    v_xor_b32 v3, s35, v1
    v_lshl_add_u32 v19, v3, 5, v30
    s_sub_u32 s36, s35, 5
    s_cmp_lt_u32 s36, 5
    s_cselect_b32 s55, s26, 0
    s_mul_i32 s47, s55, 0x358637bd
    s_mul_i32 s36, s25, 15
    s_add_u32 s36, s36, s35
    s_cmp_lt_u32 s36, 40
    s_cselect_b32 s36, 1, 0
    s_andn2_b32 s51, s36, s26
    v_add_u32 v12, 49152, v10
    v_add_u32 v13, 49152, v11
    v_add_u32 v20, 49152, v16
    v_add_u32 v21, 49152, v17
    v_add_u32 v22, 49152, v18
    v_add_u32 v23, 49152, v19
    v_add_u32 v14, 98304, v10
    v_add_u32 v15, 98304, v11
    v_add_u32 v24, 98304, v16
    v_add_u32 v25, 98304, v17
    v_add_u32 v26, 98304, v18
    v_add_u32 v27, 98304, v19
    v_mov_b32 v32, 0
    v_mov_b32 v33, 0
    v_mov_b32 v34, 0
    v_mov_b32 v35, 0
    v_mov_b32 v36, 0
    v_mov_b32 v37, 0
    v_mov_b32 v38, 0
    v_mov_b32 v39, 0
    v_mov_b32 v40, 0
    v_mov_b32 v41, 0
    v_mov_b32 v42, 0
    v_mov_b32 v43, 0
    v_mov_b32 v44, 0
    v_mov_b32 v45, 0
    v_mov_b32 v46, 0
    v_mov_b32 v47, 0
    v_mov_b32 v48, s45
    v_mov_b32 v49, s45
    v_mov_b32 v50, s45
    v_mov_b32 v51, s45
    v_mov_b32 v52, s45
    v_mov_b32 v53, s45
    v_mov_b32 v54, s45
    v_mov_b32 v55, s45
    v_mov_b32 v56, s45
    v_mov_b32 v57, s45
    v_mov_b32 v58, s45
    v_mov_b32 v59, s45
    v_mov_b32 v60, s45
    v_mov_b32 v61, s45
    v_mov_b32 v62, s45
    v_mov_b32 v63, s45
    v_mov_b32 v64, s46
    v_mov_b32 v65, s46
    v_mov_b32 v66, s46
    v_mov_b32 v67, s46
    v_mov_b32 v68, s46
    v_mov_b32 v69, s46
    v_mov_b32 v70, s46
    v_mov_b32 v71, s46
    v_mov_b32 v72, s46
    v_mov_b32 v73, s46
    v_mov_b32 v74, s46
    v_mov_b32 v75, s46
    v_mov_b32 v76, s46
    v_mov_b32 v77, s46
    v_mov_b32 v78, s46
    v_mov_b32 v79, s46
    v_mov_b32 v80, 0
    v_mov_b32 v81, 0
    v_mov_b32 v82, 0
    v_mov_b32 v83, 0
    v_mov_b32 v84, 0
    v_mov_b32 v85, 0
    v_mov_b32 v86, 0
    v_mov_b32 v87, 0
    v_mov_b32 v88, 0
    v_mov_b32 v89, 0
    v_mov_b32 v90, 0
    v_mov_b32 v91, 0
    v_mov_b32 v92, 0
    v_mov_b32 v93, 0
    v_mov_b32 v94, 0
    v_mov_b32 v95, 0
    s_add_u32 m0, s56, 49152
    s_nop 0
    buffer_load_dwordx4 v4, s[12:15], s29 offen lds
    buffer_load_dwordx4 v5, s[12:15], s29 offen offset:1024 lds
    s_add_u32 m0, s57, 49152
    s_add_u32 s29, s29, 128
    buffer_load_dwordx4 v6, s[16:19], s30 offen lds
    buffer_load_dwordx4 v7, s[16:19], s30 offen offset:1024 lds
    buffer_load_dwordx4 v8, s[16:19], s30 offen offset:2048 lds
    buffer_load_dwordx4 v9, s[16:19], s30 offen offset:3072 lds
    s_add_u32 s30, s30, 245760
    s_add_u32 s28, s28, 1
    s_cmp_eq_u32 s28, 10
    s_cselect_b32 s29, 0, s29
    s_cselect_b32 s30, 0, s30
    s_waitcnt vmcnt(7)
    s_barrier
    ds_read_b64_tr_b16 v[112:113], v16 offset:0
    ds_read_b64_tr_b16 v[114:115], v16 offset:2048
    ds_read_b128 v[96:99], v10 offset:0
    ds_read_b128 v[100:103], v10 offset:2048
    ds_read_b128 v[104:107], v10 offset:4096
    ds_read_b128 v[108:111], v10 offset:6144
    ds_read_b64_tr_b16 v[116:117], v17 offset:0
    ds_read_b64_tr_b16 v[118:119], v17 offset:2048
    ds_read_b64_tr_b16 v[120:121], v18 offset:0
    ds_read_b64_tr_b16 v[122:123], v18 offset:2048
    ds_read_b64_tr_b16 v[124:125], v19 offset:0
    ds_read_b64_tr_b16 v[126:127], v19 offset:2048
    s_add_u32 m0, s56, 98304
    s_nop 0
    buffer_load_dwordx4 v4, s[12:15], s29 offen lds
    buffer_load_dwordx4 v5, s[12:15], s29 offen offset:1024 lds
    s_add_u32 m0, s57, 98304
    s_add_u32 s29, s29, 128
    buffer_load_dwordx4 v6, s[16:19], s30 offen lds
    buffer_load_dwordx4 v7, s[16:19], s30 offen offset:1024 lds
    buffer_load_dwordx4 v8, s[16:19], s30 offen offset:2048 lds
    buffer_load_dwordx4 v9, s[16:19], s30 offen offset:3072 lds
    s_add_u32 s30, s30, 245760
    s_add_u32 s28, s28, 1
    s_cmp_eq_u32 s28, 10
    s_cselect_b32 s29, 0, s29
    s_cselect_b32 s30, 0, s30
    s_waitcnt lgkmcnt(9)
    v_mfma_f32_16x16x32_bf16 v[32:35], v[112:115], v[96:99], v[32:35]
    ds_read_b64_tr_b16 v[144:145], v16 offset:16384
    s_waitcnt lgkmcnt(9)
    v_mfma_f32_16x16x32_bf16 v[36:39], v[112:115], v[100:103], v[36:39]
    ds_read_b64_tr_b16 v[146:147], v16 offset:18432
    s_waitcnt lgkmcnt(9)
    v_mfma_f32_16x16x32_bf16 v[40:43], v[112:115], v[104:107], v[40:43]
    ds_read_b128 v[128:131], v11 offset:0
    s_waitcnt lgkmcnt(9)
    v_mfma_f32_16x16x32_bf16 v[44:47], v[112:115], v[108:111], v[44:47]
    ds_read_b128 v[132:135], v11 offset:2048
    s_waitcnt lgkmcnt(8)
    v_mfma_f32_16x16x32_bf16 v[48:51], v[116:119], v[96:99], v[48:51]
    ds_read_b128 v[136:139], v11 offset:4096
    v_mfma_f32_16x16x32_bf16 v[52:55], v[116:119], v[100:103], v[52:55]
    ds_read_b128 v[140:143], v11 offset:6144
    v_mfma_f32_16x16x32_bf16 v[56:59], v[116:119], v[104:107], v[56:59]
    ds_read_b64_tr_b16 v[148:149], v17 offset:16384
    v_mfma_f32_16x16x32_bf16 v[60:63], v[116:119], v[108:111], v[60:63]
    ds_read_b64_tr_b16 v[150:151], v17 offset:18432
    s_waitcnt lgkmcnt(10)
    v_mfma_f32_16x16x32_bf16 v[64:67], v[120:123], v[96:99], v[64:67]
    ds_read_b64_tr_b16 v[152:153], v18 offset:16384
    v_mfma_f32_16x16x32_bf16 v[68:71], v[120:123], v[100:103], v[68:71]
    ds_read_b64_tr_b16 v[154:155], v18 offset:18432
    v_mfma_f32_16x16x32_bf16 v[72:75], v[120:123], v[104:107], v[72:75]
    ds_read_b64_tr_b16 v[156:157], v19 offset:16384
    v_mfma_f32_16x16x32_bf16 v[76:79], v[120:123], v[108:111], v[76:79]
    ds_read_b64_tr_b16 v[158:159], v19 offset:18432
    s_waitcnt lgkmcnt(12)
    v_mfma_f32_16x16x32_bf16 v[80:83], v[124:127], v[96:99], v[80:83]
    v_mfma_f32_16x16x32_bf16 v[84:87], v[124:127], v[100:103], v[84:87]
    v_mfma_f32_16x16x32_bf16 v[88:91], v[124:127], v[104:107], v[88:91]
    v_mfma_f32_16x16x32_bf16 v[92:95], v[124:127], v[108:111], v[92:95]
    s_waitcnt vmcnt(6) lgkmcnt(0)
    s_barrier
    v_mfma_f32_16x16x32_bf16 v[32:35], v[144:147], v[128:131], v[32:35]
    ds_read_b64_tr_b16 v[112:113], v20 offset:0
    v_lshlrev_b32 v204, 4, v2
    v_mfma_f32_16x16x32_bf16 v[36:39], v[144:147], v[132:135], v[36:39]
    ds_read_b64_tr_b16 v[114:115], v20 offset:2048
    s_lshl_b32 s85, s2, 3
    v_mfma_f32_16x16x32_bf16 v[40:43], v[144:147], v[136:139], v[40:43]
    ds_read_b128 v[96:99], v12 offset:0
    s_add_u32 s85, s85, s33
    v_mfma_f32_16x16x32_bf16 v[44:47], v[144:147], v[140:143], v[44:47]
    ds_read_b128 v[100:103], v12 offset:2048
    s_add_u32 m0, s56, 0
    s_nop 0
    buffer_load_dwordx4 v4, s[12:15], s29 offen lds
    v_mfma_f32_16x16x32_bf16 v[48:51], v[148:151], v[128:131], v[48:51]
    ds_read_b128 v[104:107], v12 offset:4096
    s_cmp_ge_u32 s85, 800
    s_cselect_b32 s76, s80, s76
    s_cselect_b32 s77, s81, s77
    s_cselect_b32 s87, 800, 0
    s_cselect_b32 s88, 20, 0
    v_mfma_f32_16x16x32_bf16 v[52:55], v[148:151], v[132:135], v[52:55]
    ds_read_b128 v[108:111], v12 offset:6144
    buffer_load_dwordx4 v5, s[12:15], s29 offen offset:1024 lds
    v_mfma_f32_16x16x32_bf16 v[56:59], v[148:151], v[136:139], v[56:59]
    ds_read_b64_tr_b16 v[116:117], v21 offset:0
    s_mov_b32 s68, s76
    v_mfma_f32_16x16x32_bf16 v[60:63], v[148:151], v[140:143], v[60:63]
    ds_read_b64_tr_b16 v[118:119], v21 offset:2048
    s_add_u32 m0, s57, 0
    s_add_u32 s29, s29, 128
    buffer_load_dwordx4 v6, s[16:19], s30 offen lds
    v_mfma_f32_16x16x32_bf16 v[64:67], v[152:155], v[128:131], v[64:67]
    ds_read_b64_tr_b16 v[120:121], v22 offset:0
    s_and_b32 s69, s77, 0xffff
    v_mfma_f32_16x16x32_bf16 v[68:71], v[152:155], v[132:135], v[68:71]
    ds_read_b64_tr_b16 v[122:123], v22 offset:2048
    buffer_load_dwordx4 v7, s[16:19], s30 offen offset:1024 lds
    v_mfma_f32_16x16x32_bf16 v[72:75], v[152:155], v[136:139], v[72:75]
    ds_read_b64_tr_b16 v[124:125], v23 offset:0
    s_mov_b32 s70, 819200
    v_mfma_f32_16x16x32_bf16 v[76:79], v[152:155], v[140:143], v[76:79]
    ds_read_b64_tr_b16 v[126:127], v23 offset:2048
    buffer_load_dwordx4 v8, s[16:19], s30 offen offset:2048 lds
    v_mfma_f32_16x16x32_bf16 v[80:83], v[156:159], v[128:131], v[80:83]
    s_mov_b32 s71, 0x20000
    s_mov_b32 s72, s82
    v_mfma_f32_16x16x32_bf16 v[84:87], v[156:159], v[132:135], v[84:87]
    buffer_load_dwordx4 v9, s[16:19], s30 offen offset:3072 lds
    s_add_u32 s30, s30, 245760
    s_add_u32 s28, s28, 1
    s_cmp_eq_u32 s28, 10
    s_cselect_b32 s29, 0, s29
    s_cselect_b32 s30, 0, s30
    s_and_b32 s73, s83, 0xffff
    s_mov_b32 s74, 1280
    s_mov_b32 s75, 0x20000
    v_mfma_f32_16x16x32_bf16 v[88:91], v[156:159], v[136:139], v[88:91]
    s_sub_u32 s87, s85, s87
    s_mul_i32 s89, s87, 1639
    s_lshr_b32 s89, s89, 16
    v_mfma_f32_16x16x32_bf16 v[92:95], v[156:159], v[140:143], v[92:95]
    s_mul_i32 s90, s89, 40
    s_sub_u32 s90, s87, s90
    s_lshl_b32 s91, s89, 2
    s_waitcnt lgkmcnt(9)
    v_mfma_f32_16x16x32_bf16 v[32:35], v[112:115], v[96:99], v[32:35]
    ds_read_b64_tr_b16 v[144:145], v20 offset:16384
    s_lshr_b32 s34, s33, 1
    s_waitcnt lgkmcnt(9)
    v_mfma_f32_16x16x32_bf16 v[36:39], v[112:115], v[100:103], v[36:39]
    ds_read_b64_tr_b16 v[146:147], v20 offset:18432
    s_add_u32 s91, s91, s34
    s_waitcnt lgkmcnt(9)
    v_mfma_f32_16x16x32_bf16 v[40:43], v[112:115], v[104:107], v[40:43]
    ds_read_b128 v[128:131], v13 offset:0
    s_lshr_b32 s34, s91, 1
    s_waitcnt lgkmcnt(9)
    v_mfma_f32_16x16x32_bf16 v[44:47], v[112:115], v[108:111], v[44:47]
    ds_read_b128 v[132:135], v13 offset:2048
    s_mul_i32 s34, s34, 20
    s_waitcnt lgkmcnt(8)
    v_mfma_f32_16x16x32_bf16 v[48:51], v[116:119], v[96:99], v[48:51]
    ds_read_b128 v[136:139], v13 offset:4096
    s_and_b32 s35, s91, 1
    v_mfma_f32_16x16x32_bf16 v[52:55], v[116:119], v[100:103], v[52:55]
    ds_read_b128 v[140:143], v13 offset:6144
    s_lshl_b32 s35, s35, 2
    v_mfma_f32_16x16x32_bf16 v[56:59], v[116:119], v[104:107], v[56:59]
    ds_read_b64_tr_b16 v[148:149], v21 offset:16384
    s_add_u32 s34, s34, s35
    v_mfma_f32_16x16x32_bf16 v[60:63], v[116:119], v[108:111], v[60:63]
    ds_read_b64_tr_b16 v[150:151], v21 offset:18432
    s_mul_i32 s35, s91, 40
    s_waitcnt lgkmcnt(10)
    v_mfma_f32_16x16x32_bf16 v[64:67], v[120:123], v[96:99], v[64:67]
    ds_read_b64_tr_b16 v[152:153], v22 offset:16384
    s_sub_u32 s35, s35, 2544
    v_mfma_f32_16x16x32_bf16 v[68:71], v[120:123], v[100:103], v[68:71]
    ds_read_b64_tr_b16 v[154:155], v22 offset:18432
    s_cmp_lt_u32 s91, 64
    s_cselect_b32 s34, s34, s35
    s_cselect_b32 s35, 8, 20
    v_mfma_f32_16x16x32_bf16 v[72:75], v[120:123], v[104:107], v[72:75]
    ds_read_b64_tr_b16 v[156:157], v23 offset:16384
    s_and_b32 s36, s33, 1
    s_mul_i32 s35, s35, s36
    v_mfma_f32_16x16x32_bf16 v[76:79], v[120:123], v[108:111], v[76:79]
    ds_read_b64_tr_b16 v[158:159], v23 offset:18432
    s_add_u32 s34, s34, s35
    s_mul_i32 s34, s34, 1280
    s_sub_u32 s35, s90, s33
    s_waitcnt lgkmcnt(12)
    v_mfma_f32_16x16x32_bf16 v[80:83], v[124:127], v[96:99], v[80:83]
    s_lshl_b32 s35, s35, 5
    s_add_u32 s91, s34, s35
    v_lshlrev_b32 v203, 4, v29
    v_mfma_f32_16x16x32_bf16 v[84:87], v[124:127], v[100:103], v[84:87]
    v_mad_u32_u24 v200, v28, s40, v203
    v_bfe_u32 v203, v2, 2, 2
    v_lshl_add_u32 v203, v28, 3, v203
    v_mfma_f32_16x16x32_bf16 v[88:91], v[124:127], v[104:107], v[88:91]
    v_lshlrev_b32 v203, 8, v203
    v_and_b32 v201, 3, v2
    v_lshl_add_u32 v201, v201, 3, v203
    v_mfma_f32_16x16x32_bf16 v[92:95], v[124:127], v[108:111], v[92:95]
    s_lshl_b32 s34, s33, 5
    s_add_u32 s34, s34, 147456
    v_add_u32 v201, s34, v201
    s_waitcnt vmcnt(6) lgkmcnt(0)
    s_barrier
    v_mfma_f32_16x16x32_bf16 v[32:35], v[144:147], v[128:131], v[32:35]
    ds_read_b64_tr_b16 v[112:113], v24 offset:0
    s_mul_i32 s90, s90, 40
    v_mfma_f32_16x16x32_bf16 v[36:39], v[144:147], v[132:135], v[36:39]
    ds_read_b64_tr_b16 v[114:115], v24 offset:2048
    s_add_u32 s90, s90, s88
    v_mfma_f32_16x16x32_bf16 v[40:43], v[144:147], v[136:139], v[40:43]
    ds_read_b128 v[96:99], v14 offset:0
    s_add_u32 s90, s90, s89
    v_mfma_f32_16x16x32_bf16 v[44:47], v[144:147], v[140:143], v[44:47]
    ds_read_b128 v[100:103], v14 offset:2048
    s_add_u32 m0, s56, 49152
    s_nop 0
    buffer_load_dwordx4 v4, s[12:15], s29 offen lds
    v_mfma_f32_16x16x32_bf16 v[48:51], v[148:151], v[128:131], v[48:51]
    ds_read_b128 v[104:107], v14 offset:4096
    s_lshl_b32 s90, s90, 10
    v_mfma_f32_16x16x32_bf16 v[52:55], v[148:151], v[132:135], v[52:55]
    ds_read_b128 v[108:111], v14 offset:6144
    buffer_load_dwordx4 v5, s[12:15], s29 offen offset:1024 lds
    v_mfma_f32_16x16x32_bf16 v[56:59], v[148:151], v[136:139], v[56:59]
    ds_read_b64_tr_b16 v[116:117], v25 offset:0
    s_add_u32 s90, s90, 19922944
    v_mfma_f32_16x16x32_bf16 v[60:63], v[148:151], v[140:143], v[60:63]
    ds_read_b64_tr_b16 v[118:119], v25 offset:2048
    s_add_u32 m0, s57, 49152
    s_add_u32 s29, s29, 128
    buffer_load_dwordx4 v6, s[16:19], s30 offen lds
    v_mfma_f32_16x16x32_bf16 v[64:67], v[152:155], v[128:131], v[64:67]
    ds_read_b64_tr_b16 v[120:121], v26 offset:0
    s_cmp_ge_u32 s85, 1600
    s_cselect_b32 s91, 0x40000000, s91
    s_cselect_b32 s86, 0x40000000, s90
    v_mfma_f32_16x16x32_bf16 v[68:71], v[152:155], v[132:135], v[68:71]
    ds_read_b64_tr_b16 v[122:123], v26 offset:2048
    buffer_load_dwordx4 v7, s[16:19], s30 offen offset:1024 lds
    v_mfma_f32_16x16x32_bf16 v[72:75], v[152:155], v[136:139], v[72:75]
    ds_read_b64_tr_b16 v[124:125], v27 offset:0
    s_lshl_b32 s84, s24, 4
    v_mfma_f32_16x16x32_bf16 v[76:79], v[152:155], v[140:143], v[76:79]
    ds_read_b64_tr_b16 v[126:127], v27 offset:2048
    buffer_load_dwordx4 v8, s[16:19], s30 offen offset:2048 lds
    v_mfma_f32_16x16x32_bf16 v[80:83], v[156:159], v[128:131], v[80:83]
    s_add_u32 s84, s84, s43
    s_lshl_b32 s84, s84, 3
    v_mfma_f32_16x16x32_bf16 v[84:87], v[156:159], v[132:135], v[84:87]
    buffer_load_dwordx4 v9, s[16:19], s30 offen offset:3072 lds
    s_add_u32 s30, s30, 245760
    s_add_u32 s28, s28, 1
    s_cmp_eq_u32 s28, 10
    s_cselect_b32 s29, 0, s29
    s_cselect_b32 s30, 0, s30
    s_add_u32 s84, s84, s33
    s_mul_i32 s92, s84, 1280
    v_lshlrev_b32 v202, 2, v2
    v_mfma_f32_16x16x32_bf16 v[88:91], v[156:159], v[136:139], v[88:91]
    s_lshl_b32 s87, s33, 10
    v_mfma_f32_16x16x32_bf16 v[92:95], v[156:159], v[140:143], v[92:95]
    s_waitcnt lgkmcnt(9)
    v_mfma_f32_16x16x32_bf16 v[32:35], v[112:115], v[96:99], v[32:35]
    ds_read_b64_tr_b16 v[144:145], v24 offset:16384
    s_waitcnt lgkmcnt(9)
    v_mfma_f32_16x16x32_bf16 v[36:39], v[112:115], v[100:103], v[36:39]
    ds_read_b64_tr_b16 v[146:147], v24 offset:18432
    s_waitcnt lgkmcnt(9)
    v_mfma_f32_16x16x32_bf16 v[40:43], v[112:115], v[104:107], v[40:43]
    ds_read_b128 v[128:131], v15 offset:0
    s_waitcnt lgkmcnt(9)
    v_mfma_f32_16x16x32_bf16 v[44:47], v[112:115], v[108:111], v[44:47]
    ds_read_b128 v[132:135], v15 offset:2048
    s_waitcnt lgkmcnt(8)
    v_mfma_f32_16x16x32_bf16 v[48:51], v[116:119], v[96:99], v[48:51]
    ds_read_b128 v[136:139], v15 offset:4096
    v_mfma_f32_16x16x32_bf16 v[52:55], v[116:119], v[100:103], v[52:55]
    ds_read_b128 v[140:143], v15 offset:6144
    v_mfma_f32_16x16x32_bf16 v[56:59], v[116:119], v[104:107], v[56:59]
    ds_read_b64_tr_b16 v[148:149], v25 offset:16384
    v_mfma_f32_16x16x32_bf16 v[60:63], v[116:119], v[108:111], v[60:63]
    ds_read_b64_tr_b16 v[150:151], v25 offset:18432
    s_waitcnt lgkmcnt(10)
    v_mfma_f32_16x16x32_bf16 v[64:67], v[120:123], v[96:99], v[64:67]
    ds_read_b64_tr_b16 v[152:153], v26 offset:16384
    v_mfma_f32_16x16x32_bf16 v[68:71], v[120:123], v[100:103], v[68:71]
    ds_read_b64_tr_b16 v[154:155], v26 offset:18432
    v_mfma_f32_16x16x32_bf16 v[72:75], v[120:123], v[104:107], v[72:75]
    ds_read_b64_tr_b16 v[156:157], v27 offset:16384
    v_mfma_f32_16x16x32_bf16 v[76:79], v[120:123], v[108:111], v[76:79]
    ds_read_b64_tr_b16 v[158:159], v27 offset:18432
    s_waitcnt lgkmcnt(12)
    v_mfma_f32_16x16x32_bf16 v[80:83], v[124:127], v[96:99], v[80:83]
    v_mfma_f32_16x16x32_bf16 v[84:87], v[124:127], v[100:103], v[84:87]
    v_mfma_f32_16x16x32_bf16 v[88:91], v[124:127], v[104:107], v[88:91]
    v_mfma_f32_16x16x32_bf16 v[92:95], v[124:127], v[108:111], v[92:95]
    s_waitcnt vmcnt(6) lgkmcnt(0)
    s_barrier
    v_mfma_f32_16x16x32_bf16 v[32:35], v[144:147], v[128:131], v[32:35]
    ds_read_b64_tr_b16 v[112:113], v16 offset:0
    v_mfma_f32_16x16x32_bf16 v[36:39], v[144:147], v[132:135], v[36:39]
    ds_read_b64_tr_b16 v[114:115], v16 offset:2048
    v_mfma_f32_16x16x32_bf16 v[40:43], v[144:147], v[136:139], v[40:43]
    ds_read_b128 v[96:99], v10 offset:0
    v_mfma_f32_16x16x32_bf16 v[44:47], v[144:147], v[140:143], v[44:47]
    ds_read_b128 v[100:103], v10 offset:2048
    s_add_u32 m0, s56, 98304
    s_nop 0
    buffer_load_dwordx4 v4, s[12:15], s29 offen lds
    v_mfma_f32_16x16x32_bf16 v[48:51], v[148:151], v[128:131], v[48:51]
    ds_read_b128 v[104:107], v10 offset:4096
    v_mfma_f32_16x16x32_bf16 v[52:55], v[148:151], v[132:135], v[52:55]
    ds_read_b128 v[108:111], v10 offset:6144
    buffer_load_dwordx4 v5, s[12:15], s29 offen offset:1024 lds
    v_mfma_f32_16x16x32_bf16 v[56:59], v[148:151], v[136:139], v[56:59]
    ds_read_b64_tr_b16 v[116:117], v17 offset:0
    v_mfma_f32_16x16x32_bf16 v[60:63], v[148:151], v[140:143], v[60:63]
    ds_read_b64_tr_b16 v[118:119], v17 offset:2048
    s_add_u32 m0, s57, 98304
    s_add_u32 s29, s29, 128
    buffer_load_dwordx4 v6, s[16:19], s30 offen lds
    v_mfma_f32_16x16x32_bf16 v[64:67], v[152:155], v[128:131], v[64:67]
    ds_read_b64_tr_b16 v[120:121], v18 offset:0
    v_mfma_f32_16x16x32_bf16 v[68:71], v[152:155], v[132:135], v[68:71]
    ds_read_b64_tr_b16 v[122:123], v18 offset:2048
    buffer_load_dwordx4 v7, s[16:19], s30 offen offset:1024 lds
    v_mfma_f32_16x16x32_bf16 v[72:75], v[152:155], v[136:139], v[72:75]
    ds_read_b64_tr_b16 v[124:125], v19 offset:0
    v_mfma_f32_16x16x32_bf16 v[76:79], v[152:155], v[140:143], v[76:79]
    ds_read_b64_tr_b16 v[126:127], v19 offset:2048
    buffer_load_dwordx4 v8, s[16:19], s30 offen offset:2048 lds
    v_mfma_f32_16x16x32_bf16 v[80:83], v[156:159], v[128:131], v[80:83]
    v_mfma_f32_16x16x32_bf16 v[84:87], v[156:159], v[132:135], v[84:87]
    buffer_load_dwordx4 v9, s[16:19], s30 offen offset:3072 lds
    s_add_u32 s30, s30, 245760
    s_add_u32 s28, s28, 1
    s_cmp_eq_u32 s28, 10
    s_cselect_b32 s29, 0, s29
    s_cselect_b32 s30, 0, s30
    v_mfma_f32_16x16x32_bf16 v[88:91], v[156:159], v[136:139], v[88:91]
    v_mfma_f32_16x16x32_bf16 v[92:95], v[156:159], v[140:143], v[92:95]
    s_waitcnt lgkmcnt(9)
    v_mfma_f32_16x16x32_bf16 v[32:35], v[112:115], v[96:99], v[32:35]
    ds_read_b64_tr_b16 v[144:145], v16 offset:16384
    s_add_u32 m0, s87, 147456
    s_nop 0
    buffer_load_dwordx4 v200, s[68:71], s91 offen lds
    s_waitcnt lgkmcnt(9)
    v_mfma_f32_16x16x32_bf16 v[36:39], v[112:115], v[100:103], v[36:39]
    ds_read_b64_tr_b16 v[146:147], v16 offset:18432
    s_add_u32 m0, s87, 155648
    s_nop 0
    buffer_load_dwordx4 v204, s[72:75], s87 offen lds
    s_waitcnt lgkmcnt(9)
    v_mfma_f32_16x16x32_bf16 v[40:43], v[112:115], v[104:107], v[40:43]
    ds_read_b128 v[128:131], v11 offset:0
    buffer_load_dwordx4 v[160:163], v204, s[12:15], s92 offen
    s_waitcnt lgkmcnt(9)
    v_mfma_f32_16x16x32_bf16 v[44:47], v[112:115], v[108:111], v[44:47]
    ds_read_b128 v[132:135], v11 offset:2048
    buffer_load_dword v164, v202, s[12:15], s92 offen offset:1024
    s_waitcnt lgkmcnt(8)
    v_mfma_f32_16x16x32_bf16 v[48:51], v[116:119], v[96:99], v[48:51]
    ds_read_b128 v[136:139], v11 offset:4096
    v_mfma_f32_16x16x32_bf16 v[52:55], v[116:119], v[100:103], v[52:55]
    ds_read_b128 v[140:143], v11 offset:6144
    v_mfma_f32_16x16x32_bf16 v[56:59], v[116:119], v[104:107], v[56:59]
    ds_read_b64_tr_b16 v[148:149], v17 offset:16384
    v_mfma_f32_16x16x32_bf16 v[60:63], v[116:119], v[108:111], v[60:63]
    ds_read_b64_tr_b16 v[150:151], v17 offset:18432
    s_waitcnt lgkmcnt(10)
    v_mfma_f32_16x16x32_bf16 v[64:67], v[120:123], v[96:99], v[64:67]
    ds_read_b64_tr_b16 v[152:153], v18 offset:16384
    v_mfma_f32_16x16x32_bf16 v[68:71], v[120:123], v[100:103], v[68:71]
    ds_read_b64_tr_b16 v[154:155], v18 offset:18432
    v_mfma_f32_16x16x32_bf16 v[72:75], v[120:123], v[104:107], v[72:75]
    ds_read_b64_tr_b16 v[156:157], v19 offset:16384
    v_mfma_f32_16x16x32_bf16 v[76:79], v[120:123], v[108:111], v[76:79]
    ds_read_b64_tr_b16 v[158:159], v19 offset:18432
    s_waitcnt lgkmcnt(12)
    v_mfma_f32_16x16x32_bf16 v[80:83], v[124:127], v[96:99], v[80:83]
    v_mfma_f32_16x16x32_bf16 v[84:87], v[124:127], v[100:103], v[84:87]
    v_mfma_f32_16x16x32_bf16 v[88:91], v[124:127], v[104:107], v[88:91]
    v_mfma_f32_16x16x32_bf16 v[92:95], v[124:127], v[108:111], v[92:95]
    s_waitcnt vmcnt(10) lgkmcnt(0)
    s_barrier
    v_mfma_f32_16x16x32_bf16 v[32:35], v[144:147], v[128:131], v[32:35]
    ds_read_b64_tr_b16 v[112:113], v20 offset:0
    v_mfma_f32_16x16x32_bf16 v[36:39], v[144:147], v[132:135], v[36:39]
    ds_read_b64_tr_b16 v[114:115], v20 offset:2048
    v_mfma_f32_16x16x32_bf16 v[40:43], v[144:147], v[136:139], v[40:43]
    ds_read_b128 v[96:99], v12 offset:0
    v_mfma_f32_16x16x32_bf16 v[44:47], v[144:147], v[140:143], v[44:47]
    ds_read_b128 v[100:103], v12 offset:2048
    s_add_u32 m0, s56, 0
    s_nop 0
    buffer_load_dwordx4 v4, s[12:15], s29 offen lds
    v_mfma_f32_16x16x32_bf16 v[48:51], v[148:151], v[128:131], v[48:51]
    ds_read_b128 v[104:107], v12 offset:4096
    v_mfma_f32_16x16x32_bf16 v[52:55], v[148:151], v[132:135], v[52:55]
    ds_read_b128 v[108:111], v12 offset:6144
    buffer_load_dwordx4 v5, s[12:15], s29 offen offset:1024 lds
    v_mfma_f32_16x16x32_bf16 v[56:59], v[148:151], v[136:139], v[56:59]
    ds_read_b64_tr_b16 v[116:117], v21 offset:0
    v_mfma_f32_16x16x32_bf16 v[60:63], v[148:151], v[140:143], v[60:63]
    ds_read_b64_tr_b16 v[118:119], v21 offset:2048
    s_add_u32 m0, s57, 0
    s_add_u32 s29, s29, 128
    buffer_load_dwordx4 v6, s[16:19], s30 offen lds
    v_mfma_f32_16x16x32_bf16 v[64:67], v[152:155], v[128:131], v[64:67]
    ds_read_b64_tr_b16 v[120:121], v22 offset:0
    v_mfma_f32_16x16x32_bf16 v[68:71], v[152:155], v[132:135], v[68:71]
    ds_read_b64_tr_b16 v[122:123], v22 offset:2048
    buffer_load_dwordx4 v7, s[16:19], s30 offen offset:1024 lds
    v_mfma_f32_16x16x32_bf16 v[72:75], v[152:155], v[136:139], v[72:75]
    ds_read_b64_tr_b16 v[124:125], v23 offset:0
    v_mfma_f32_16x16x32_bf16 v[76:79], v[152:155], v[140:143], v[76:79]
    ds_read_b64_tr_b16 v[126:127], v23 offset:2048
    buffer_load_dwordx4 v8, s[16:19], s30 offen offset:2048 lds
    v_mfma_f32_16x16x32_bf16 v[80:83], v[156:159], v[128:131], v[80:83]
    v_mfma_f32_16x16x32_bf16 v[84:87], v[156:159], v[132:135], v[84:87]
    buffer_load_dwordx4 v9, s[16:19], s30 offen offset:3072 lds
    s_add_u32 s30, s30, 245760
    s_add_u32 s28, s28, 1
    s_cmp_eq_u32 s28, 10
    s_cselect_b32 s29, 0, s29
    s_cselect_b32 s30, 0, s30
    v_mfma_f32_16x16x32_bf16 v[88:91], v[156:159], v[136:139], v[88:91]
    v_mfma_f32_16x16x32_bf16 v[92:95], v[156:159], v[140:143], v[92:95]
    s_waitcnt lgkmcnt(9)
    v_mfma_f32_16x16x32_bf16 v[32:35], v[112:115], v[96:99], v[32:35]
    ds_read_b64_tr_b16 v[144:145], v20 offset:16384
    v_mov_b32 v208, 0
    s_waitcnt lgkmcnt(9)
    v_mfma_f32_16x16x32_bf16 v[36:39], v[112:115], v[100:103], v[36:39]
    ds_read_b64_tr_b16 v[146:147], v20 offset:18432
    global_load_dword v208, v208, s[96:97] sc1
    s_waitcnt lgkmcnt(9)
    v_mfma_f32_16x16x32_bf16 v[40:43], v[112:115], v[104:107], v[40:43]
    ds_read_b128 v[128:131], v13 offset:0
    s_waitcnt lgkmcnt(9)
    v_mfma_f32_16x16x32_bf16 v[44:47], v[112:115], v[108:111], v[44:47]
    ds_read_b128 v[132:135], v13 offset:2048
    s_waitcnt lgkmcnt(8)
    v_mfma_f32_16x16x32_bf16 v[48:51], v[116:119], v[96:99], v[48:51]
    ds_read_b128 v[136:139], v13 offset:4096
    v_mfma_f32_16x16x32_bf16 v[52:55], v[116:119], v[100:103], v[52:55]
    ds_read_b128 v[140:143], v13 offset:6144
    v_mfma_f32_16x16x32_bf16 v[56:59], v[116:119], v[104:107], v[56:59]
    ds_read_b64_tr_b16 v[148:149], v21 offset:16384
    v_mfma_f32_16x16x32_bf16 v[60:63], v[116:119], v[108:111], v[60:63]
    ds_read_b64_tr_b16 v[150:151], v21 offset:18432
    s_waitcnt lgkmcnt(10)
    v_mfma_f32_16x16x32_bf16 v[64:67], v[120:123], v[96:99], v[64:67]
    ds_read_b64_tr_b16 v[152:153], v22 offset:16384
    v_mfma_f32_16x16x32_bf16 v[68:71], v[120:123], v[100:103], v[68:71]
    ds_read_b64_tr_b16 v[154:155], v22 offset:18432
    v_mfma_f32_16x16x32_bf16 v[72:75], v[120:123], v[104:107], v[72:75]
    ds_read_b64_tr_b16 v[156:157], v23 offset:16384
    v_mfma_f32_16x16x32_bf16 v[76:79], v[120:123], v[108:111], v[76:79]
    ds_read_b64_tr_b16 v[158:159], v23 offset:18432
    s_waitcnt lgkmcnt(12)
    v_mfma_f32_16x16x32_bf16 v[80:83], v[124:127], v[96:99], v[80:83]
    v_mfma_f32_16x16x32_bf16 v[84:87], v[124:127], v[100:103], v[84:87]
    v_mfma_f32_16x16x32_bf16 v[88:91], v[124:127], v[104:107], v[88:91]
    v_mfma_f32_16x16x32_bf16 v[92:95], v[124:127], v[108:111], v[92:95]
    s_waitcnt vmcnt(11) lgkmcnt(0)
    s_barrier
    v_mfma_f32_16x16x32_bf16 v[32:35], v[144:147], v[128:131], v[32:35]
    ds_read_b64_tr_b16 v[112:113], v24 offset:0
    v_mfma_f32_16x16x32_bf16 v[36:39], v[144:147], v[132:135], v[36:39]
    ds_read_b64_tr_b16 v[114:115], v24 offset:2048
    v_mfma_f32_16x16x32_bf16 v[40:43], v[144:147], v[136:139], v[40:43]
    ds_read_b128 v[96:99], v14 offset:0
    v_mfma_f32_16x16x32_bf16 v[44:47], v[144:147], v[140:143], v[44:47]
    ds_read_b128 v[100:103], v14 offset:2048
    s_add_u32 m0, s56, 49152
    s_nop 0
    buffer_load_dwordx4 v4, s[12:15], s29 offen lds
    v_mfma_f32_16x16x32_bf16 v[48:51], v[148:151], v[128:131], v[48:51]
    ds_read_b128 v[104:107], v14 offset:4096
    v_mfma_f32_16x16x32_bf16 v[52:55], v[148:151], v[132:135], v[52:55]
    ds_read_b128 v[108:111], v14 offset:6144
    buffer_load_dwordx4 v5, s[12:15], s29 offen offset:1024 lds
    v_mfma_f32_16x16x32_bf16 v[56:59], v[148:151], v[136:139], v[56:59]
    ds_read_b64_tr_b16 v[116:117], v25 offset:0
    v_mfma_f32_16x16x32_bf16 v[60:63], v[148:151], v[140:143], v[60:63]
    ds_read_b64_tr_b16 v[118:119], v25 offset:2048
    s_add_u32 m0, s57, 49152
    s_add_u32 s29, s29, 128
    buffer_load_dwordx4 v6, s[16:19], s30 offen lds
    v_mfma_f32_16x16x32_bf16 v[64:67], v[152:155], v[128:131], v[64:67]
    ds_read_b64_tr_b16 v[120:121], v26 offset:0
    v_mfma_f32_16x16x32_bf16 v[68:71], v[152:155], v[132:135], v[68:71]
    ds_read_b64_tr_b16 v[122:123], v26 offset:2048
    buffer_load_dwordx4 v7, s[16:19], s30 offen offset:1024 lds
    v_mfma_f32_16x16x32_bf16 v[72:75], v[152:155], v[136:139], v[72:75]
    ds_read_b64_tr_b16 v[124:125], v27 offset:0
    v_mfma_f32_16x16x32_bf16 v[76:79], v[152:155], v[140:143], v[76:79]
    ds_read_b64_tr_b16 v[126:127], v27 offset:2048
    buffer_load_dwordx4 v8, s[16:19], s30 offen offset:2048 lds
    v_mfma_f32_16x16x32_bf16 v[80:83], v[156:159], v[128:131], v[80:83]
    v_mfma_f32_16x16x32_bf16 v[84:87], v[156:159], v[132:135], v[84:87]
    buffer_load_dwordx4 v9, s[16:19], s30 offen offset:3072 lds
    s_add_u32 s30, s30, 245760
    s_add_u32 s28, s28, 1
    s_cmp_eq_u32 s28, 10
    s_cselect_b32 s29, 0, s29
    s_cselect_b32 s30, 0, s30
    v_mfma_f32_16x16x32_bf16 v[88:91], v[156:159], v[136:139], v[88:91]
    v_mfma_f32_16x16x32_bf16 v[92:95], v[156:159], v[140:143], v[92:95]
    s_waitcnt lgkmcnt(9)
    v_mfma_f32_16x16x32_bf16 v[32:35], v[112:115], v[96:99], v[32:35]
    ds_read_b64_tr_b16 v[144:145], v24 offset:16384
    s_waitcnt lgkmcnt(9)
    v_mfma_f32_16x16x32_bf16 v[36:39], v[112:115], v[100:103], v[36:39]
    ds_read_b64_tr_b16 v[146:147], v24 offset:18432
    s_waitcnt lgkmcnt(9)
    v_mfma_f32_16x16x32_bf16 v[40:43], v[112:115], v[104:107], v[40:43]
    ds_read_b128 v[128:131], v15 offset:0
    s_waitcnt lgkmcnt(9)
    v_mfma_f32_16x16x32_bf16 v[44:47], v[112:115], v[108:111], v[44:47]
    ds_read_b128 v[132:135], v15 offset:2048
    s_waitcnt lgkmcnt(8)
    v_mfma_f32_16x16x32_bf16 v[48:51], v[116:119], v[96:99], v[48:51]
    ds_read_b128 v[136:139], v15 offset:4096
    v_mfma_f32_16x16x32_bf16 v[52:55], v[116:119], v[100:103], v[52:55]
    ds_read_b128 v[140:143], v15 offset:6144
    v_mfma_f32_16x16x32_bf16 v[56:59], v[116:119], v[104:107], v[56:59]
    ds_read_b64_tr_b16 v[148:149], v25 offset:16384
    v_mfma_f32_16x16x32_bf16 v[60:63], v[116:119], v[108:111], v[60:63]
    ds_read_b64_tr_b16 v[150:151], v25 offset:18432
    s_waitcnt lgkmcnt(10)
    v_mfma_f32_16x16x32_bf16 v[64:67], v[120:123], v[96:99], v[64:67]
    ds_read_b64_tr_b16 v[152:153], v26 offset:16384
    v_mfma_f32_16x16x32_bf16 v[68:71], v[120:123], v[100:103], v[68:71]
    ds_read_b64_tr_b16 v[154:155], v26 offset:18432
    v_mfma_f32_16x16x32_bf16 v[72:75], v[120:123], v[104:107], v[72:75]
    ds_read_b64_tr_b16 v[156:157], v27 offset:16384
    v_mfma_f32_16x16x32_bf16 v[76:79], v[120:123], v[108:111], v[76:79]
    ds_read_b64_tr_b16 v[158:159], v27 offset:18432
    s_waitcnt lgkmcnt(12)
    v_mfma_f32_16x16x32_bf16 v[80:83], v[124:127], v[96:99], v[80:83]
    v_mfma_f32_16x16x32_bf16 v[84:87], v[124:127], v[100:103], v[84:87]
    v_mfma_f32_16x16x32_bf16 v[88:91], v[124:127], v[104:107], v[88:91]
    v_mfma_f32_16x16x32_bf16 v[92:95], v[124:127], v[108:111], v[92:95]
    s_waitcnt vmcnt(7) lgkmcnt(0)
    s_barrier
    v_mfma_f32_16x16x32_bf16 v[32:35], v[144:147], v[128:131], v[32:35]
    ds_read_b64_tr_b16 v[112:113], v16 offset:0
    ds_read_b64_tr_b16 v[192:193], v201
    v_mfma_f32_16x16x32_bf16 v[36:39], v[144:147], v[132:135], v[36:39]
    ds_read_b64_tr_b16 v[114:115], v16 offset:2048
    ds_read_b64_tr_b16 v[194:195], v201 offset:1024
    v_mfma_f32_16x16x32_bf16 v[40:43], v[144:147], v[136:139], v[40:43]
    ds_read_b128 v[96:99], v10 offset:0
    v_add_u32 v200, 155648, v204
    v_mfma_f32_16x16x32_bf16 v[44:47], v[144:147], v[140:143], v[44:47]
    ds_read_b128 v[100:103], v10 offset:2048
    s_add_u32 m0, s56, 98304
    s_nop 0
    buffer_load_dwordx4 v4, s[12:15], s29 offen lds
    v_mfma_f32_16x16x32_bf16 v[48:51], v[148:151], v[128:131], v[48:51]
    ds_read_b128 v[104:107], v10 offset:4096
    v_add_u32 v203, 155648, v202
    v_mfma_f32_16x16x32_bf16 v[52:55], v[148:151], v[132:135], v[52:55]
    ds_read_b128 v[108:111], v10 offset:6144
    buffer_load_dwordx4 v5, s[12:15], s29 offen offset:1024 lds
    v_mfma_f32_16x16x32_bf16 v[56:59], v[148:151], v[136:139], v[56:59]
    ds_read_b64_tr_b16 v[116:117], v17 offset:0
    ds_read_b128 v[166:169], v200
    v_mfma_f32_16x16x32_bf16 v[60:63], v[148:151], v[140:143], v[60:63]
    ds_read_b64_tr_b16 v[118:119], v17 offset:2048
    s_add_u32 m0, s57, 98304
    s_add_u32 s29, s29, 128
    buffer_load_dwordx4 v6, s[16:19], s30 offen lds
    v_mfma_f32_16x16x32_bf16 v[64:67], v[152:155], v[128:131], v[64:67]
    ds_read_b64_tr_b16 v[120:121], v18 offset:0
    ds_read_b32 v170, v203 offset:1024
    v_mfma_f32_16x16x32_bf16 v[68:71], v[152:155], v[132:135], v[68:71]
    ds_read_b64_tr_b16 v[122:123], v18 offset:2048
    buffer_load_dwordx4 v7, s[16:19], s30 offen offset:1024 lds
    v_mfma_f32_16x16x32_bf16 v[72:75], v[152:155], v[136:139], v[72:75]
    ds_read_b64_tr_b16 v[124:125], v19 offset:0
    v_mfma_f32_16x16x32_bf16 v[76:79], v[152:155], v[140:143], v[76:79]
    ds_read_b64_tr_b16 v[126:127], v19 offset:2048
    buffer_load_dwordx4 v8, s[16:19], s30 offen offset:2048 lds
    v_mfma_f32_16x16x32_bf16 v[80:83], v[156:159], v[128:131], v[80:83]
    v_mfma_f32_16x16x32_bf16 v[84:87], v[156:159], v[132:135], v[84:87]
    buffer_load_dwordx4 v9, s[16:19], s30 offen offset:3072 lds
    s_add_u32 s30, s30, 245760
    s_add_u32 s28, s28, 1
    s_cmp_eq_u32 s28, 10
    s_cselect_b32 s29, 0, s29
    s_cselect_b32 s30, 0, s30
    v_mfma_f32_16x16x32_bf16 v[88:91], v[156:159], v[136:139], v[88:91]
    v_mfma_f32_16x16x32_bf16 v[92:95], v[156:159], v[140:143], v[92:95]
    s_waitcnt lgkmcnt(11)
    v_mfma_f32_16x16x32_bf16 v[32:35], v[112:115], v[96:99], v[32:35]
    ds_read_b64_tr_b16 v[144:145], v16 offset:16384
    buffer_store_dwordx4 v[192:195], v204, s[20:23], s86 offen sc1
    s_waitcnt lgkmcnt(11)
    v_mfma_f32_16x16x32_bf16 v[36:39], v[112:115], v[100:103], v[36:39]
    ds_read_b64_tr_b16 v[146:147], v16 offset:18432
    v_lshlrev_b32 v172, 16, v160
    s_waitcnt lgkmcnt(11)
    v_mfma_f32_16x16x32_bf16 v[40:43], v[112:115], v[104:107], v[40:43]
    ds_read_b128 v[128:131], v11 offset:0
    v_and_b32 v173, 0xffff0000, v160
    s_waitcnt lgkmcnt(11)
    v_mfma_f32_16x16x32_bf16 v[44:47], v[112:115], v[108:111], v[44:47]
    ds_read_b128 v[132:135], v11 offset:2048
    s_waitcnt lgkmcnt(10)
    v_lshlrev_b32 v174, 16, v166
    s_waitcnt lgkmcnt(9)
    v_mfma_f32_16x16x32_bf16 v[48:51], v[116:119], v[96:99], v[48:51]
    ds_read_b128 v[136:139], v11 offset:4096
    v_and_b32 v175, 0xffff0000, v166
    v_mfma_f32_16x16x32_bf16 v[52:55], v[116:119], v[100:103], v[52:55]
    ds_read_b128 v[140:143], v11 offset:6144
    v_lshlrev_b32 v176, 16, v161
    v_mfma_f32_16x16x32_bf16 v[56:59], v[116:119], v[104:107], v[56:59]
    ds_read_b64_tr_b16 v[148:149], v17 offset:16384
    v_and_b32 v177, 0xffff0000, v161
    v_mfma_f32_16x16x32_bf16 v[60:63], v[116:119], v[108:111], v[60:63]
    ds_read_b64_tr_b16 v[150:151], v17 offset:18432
    v_lshlrev_b32 v178, 16, v167
    s_waitcnt lgkmcnt(10)
    v_mfma_f32_16x16x32_bf16 v[64:67], v[120:123], v[96:99], v[64:67]
    ds_read_b64_tr_b16 v[152:153], v18 offset:16384
    v_and_b32 v179, 0xffff0000, v167
    v_mfma_f32_16x16x32_bf16 v[68:71], v[120:123], v[100:103], v[68:71]
    ds_read_b64_tr_b16 v[154:155], v18 offset:18432
    v_lshlrev_b32 v180, 16, v162
    v_mfma_f32_16x16x32_bf16 v[72:75], v[120:123], v[104:107], v[72:75]
    ds_read_b64_tr_b16 v[156:157], v19 offset:16384
    v_and_b32 v181, 0xffff0000, v162
    v_mfma_f32_16x16x32_bf16 v[76:79], v[120:123], v[108:111], v[76:79]
    ds_read_b64_tr_b16 v[158:159], v19 offset:18432
    v_lshlrev_b32 v182, 16, v168
    v_and_b32 v183, 0xffff0000, v168
    v_lshlrev_b32 v184, 16, v163
    s_waitcnt lgkmcnt(12)
    v_mfma_f32_16x16x32_bf16 v[80:83], v[124:127], v[96:99], v[80:83]
    v_and_b32 v185, 0xffff0000, v163
    v_lshlrev_b32 v186, 16, v169
    v_and_b32 v187, 0xffff0000, v169
    v_mfma_f32_16x16x32_bf16 v[84:87], v[124:127], v[100:103], v[84:87]
    v_lshlrev_b32 v188, 16, v164
    v_and_b32 v189, 0xffff0000, v164
    v_lshlrev_b32 v190, 16, v170
    v_mfma_f32_16x16x32_bf16 v[88:91], v[124:127], v[104:107], v[88:91]
    v_and_b32 v191, 0xffff0000, v170
    v_mfma_f32_16x16x32_bf16 v[92:95], v[124:127], v[108:111], v[92:95]
    s_waitcnt vmcnt(7) lgkmcnt(0)
    s_barrier
    v_mfma_f32_16x16x32_bf16 v[32:35], v[144:147], v[128:131], v[32:35]
    ds_read_b64_tr_b16 v[112:113], v20 offset:0
    v_mul_f32 v172, v172, v174
    v_mfma_f32_16x16x32_bf16 v[36:39], v[144:147], v[132:135], v[36:39]
    ds_read_b64_tr_b16 v[114:115], v20 offset:2048
    v_mul_f32 v173, v173, v175
    v_mfma_f32_16x16x32_bf16 v[40:43], v[144:147], v[136:139], v[40:43]
    ds_read_b128 v[96:99], v12 offset:0
    v_mul_f32 v176, v176, v178
    v_mfma_f32_16x16x32_bf16 v[44:47], v[144:147], v[140:143], v[44:47]
    ds_read_b128 v[100:103], v12 offset:2048
    s_add_u32 m0, s56, 0
    s_nop 0
    buffer_load_dwordx4 v4, s[12:15], s29 offen lds
    v_mfma_f32_16x16x32_bf16 v[48:51], v[148:151], v[128:131], v[48:51]
    ds_read_b128 v[104:107], v12 offset:4096
    v_mul_f32 v177, v177, v179
    v_mfma_f32_16x16x32_bf16 v[52:55], v[148:151], v[132:135], v[52:55]
    ds_read_b128 v[108:111], v12 offset:6144
    buffer_load_dwordx4 v5, s[12:15], s29 offen offset:1024 lds
    v_mfma_f32_16x16x32_bf16 v[56:59], v[148:151], v[136:139], v[56:59]
    ds_read_b64_tr_b16 v[116:117], v21 offset:0
    v_mul_f32 v180, v180, v182
    v_mfma_f32_16x16x32_bf16 v[60:63], v[148:151], v[140:143], v[60:63]
    ds_read_b64_tr_b16 v[118:119], v21 offset:2048
    s_add_u32 m0, s57, 0
    s_add_u32 s29, s29, 128
    buffer_load_dwordx4 v6, s[16:19], s30 offen lds
    v_mfma_f32_16x16x32_bf16 v[64:67], v[152:155], v[128:131], v[64:67]
    ds_read_b64_tr_b16 v[120:121], v22 offset:0
    v_mul_f32 v181, v181, v183
    v_mfma_f32_16x16x32_bf16 v[68:71], v[152:155], v[132:135], v[68:71]
    ds_read_b64_tr_b16 v[122:123], v22 offset:2048
    buffer_load_dwordx4 v7, s[16:19], s30 offen offset:1024 lds
    v_mfma_f32_16x16x32_bf16 v[72:75], v[152:155], v[136:139], v[72:75]
    ds_read_b64_tr_b16 v[124:125], v23 offset:0
    v_mul_f32 v184, v184, v186
    v_mfma_f32_16x16x32_bf16 v[76:79], v[152:155], v[140:143], v[76:79]
    ds_read_b64_tr_b16 v[126:127], v23 offset:2048
    buffer_load_dwordx4 v8, s[16:19], s30 offen offset:2048 lds
    v_mfma_f32_16x16x32_bf16 v[80:83], v[156:159], v[128:131], v[80:83]
    v_mul_f32 v185, v185, v187
    v_mul_f32 v188, v188, v190
    v_mfma_f32_16x16x32_bf16 v[84:87], v[156:159], v[132:135], v[84:87]
    buffer_load_dwordx4 v9, s[16:19], s30 offen offset:3072 lds
    v_mul_f32 v189, v189, v191
    v_cvt_pk_bf16_f32 v174, v172, v173
    v_cvt_pk_bf16_f32 v178, v176, v177
    v_mfma_f32_16x16x32_bf16 v[88:91], v[156:159], v[136:139], v[88:91]
    v_cvt_pk_bf16_f32 v182, v180, v181
    v_cvt_pk_bf16_f32 v186, v184, v185
    v_cvt_pk_bf16_f32 v190, v188, v189
    v_mfma_f32_16x16x32_bf16 v[92:95], v[156:159], v[140:143], v[92:95]
    s_waitcnt lgkmcnt(9)
    v_mfma_f32_16x16x32_bf16 v[32:35], v[112:115], v[96:99], v[32:35]
    ds_read_b64_tr_b16 v[144:145], v20 offset:16384
    v_lshlrev_b32 v172, 16, v174
    s_waitcnt lgkmcnt(9)
    v_mfma_f32_16x16x32_bf16 v[36:39], v[112:115], v[100:103], v[36:39]
    ds_read_b64_tr_b16 v[146:147], v20 offset:18432
    v_and_b32 v173, 0xffff0000, v174
    s_waitcnt lgkmcnt(9)
    v_mfma_f32_16x16x32_bf16 v[40:43], v[112:115], v[104:107], v[40:43]
    ds_read_b128 v[128:131], v13 offset:0
    v_lshlrev_b32 v176, 16, v178
    s_waitcnt lgkmcnt(9)
    v_mfma_f32_16x16x32_bf16 v[44:47], v[112:115], v[108:111], v[44:47]
    ds_read_b128 v[132:135], v13 offset:2048
    v_and_b32 v177, 0xffff0000, v178
    s_waitcnt lgkmcnt(8)
    v_mfma_f32_16x16x32_bf16 v[48:51], v[116:119], v[96:99], v[48:51]
    ds_read_b128 v[136:139], v13 offset:4096
    v_lshlrev_b32 v180, 16, v182
    v_mfma_f32_16x16x32_bf16 v[52:55], v[116:119], v[100:103], v[52:55]
    ds_read_b128 v[140:143], v13 offset:6144
    v_and_b32 v181, 0xffff0000, v182
    v_mfma_f32_16x16x32_bf16 v[56:59], v[116:119], v[104:107], v[56:59]
    ds_read_b64_tr_b16 v[148:149], v21 offset:16384
    v_lshlrev_b32 v184, 16, v186
    v_mfma_f32_16x16x32_bf16 v[60:63], v[116:119], v[108:111], v[60:63]
    ds_read_b64_tr_b16 v[150:151], v21 offset:18432
    v_and_b32 v185, 0xffff0000, v186
    s_waitcnt lgkmcnt(10)
    v_mfma_f32_16x16x32_bf16 v[64:67], v[120:123], v[96:99], v[64:67]
    ds_read_b64_tr_b16 v[152:153], v22 offset:16384
    v_lshlrev_b32 v188, 16, v190
    v_mfma_f32_16x16x32_bf16 v[68:71], v[120:123], v[100:103], v[68:71]
    ds_read_b64_tr_b16 v[154:155], v22 offset:18432
    v_and_b32 v189, 0xffff0000, v190
    v_mfma_f32_16x16x32_bf16 v[72:75], v[120:123], v[104:107], v[72:75]
    ds_read_b64_tr_b16 v[156:157], v23 offset:16384
    v_add_f32 v172, v172, v173
    v_mfma_f32_16x16x32_bf16 v[76:79], v[120:123], v[108:111], v[76:79]
    ds_read_b64_tr_b16 v[158:159], v23 offset:18432
    v_add_f32 v176, v176, v177
    v_add_f32 v180, v180, v181
    v_add_f32 v184, v184, v185
    s_waitcnt lgkmcnt(12)
    v_mfma_f32_16x16x32_bf16 v[80:83], v[124:127], v[96:99], v[80:83]
    v_add_f32 v188, v188, v189
    v_add_f32 v172, v172, v176
    v_add_f32 v180, v180, v184
    v_mfma_f32_16x16x32_bf16 v[84:87], v[124:127], v[100:103], v[84:87]
    v_add_f32 v172, v172, v188
    v_add_f32 v172, v172, v180
    v_mfma_f32_16x16x32_bf16 v[88:91], v[124:127], v[104:107], v[88:91]
    v_mfma_f32_16x16x32_bf16 v[92:95], v[124:127], v[108:111], v[92:95]
    s_waitcnt vmcnt(7) lgkmcnt(0)
    s_barrier
    v_mfma_f32_16x16x32_bf16 v[32:35], v[144:147], v[128:131], v[32:35]
    ds_read_b64_tr_b16 v[112:113], v24 offset:0
    v_add_f32_dpp v172, v172, v172 row_shr:1 row_mask:0xf bank_mask:0xf
    v_mfma_f32_16x16x32_bf16 v[36:39], v[144:147], v[132:135], v[36:39]
    ds_read_b64_tr_b16 v[114:115], v24 offset:2048
    v_mfma_f32_16x16x32_bf16 v[40:43], v[144:147], v[136:139], v[40:43]
    ds_read_b128 v[96:99], v14 offset:0
    v_add_f32_dpp v172, v172, v172 row_shr:2 row_mask:0xf bank_mask:0xf
    v_mfma_f32_16x16x32_bf16 v[44:47], v[144:147], v[140:143], v[44:47]
    ds_read_b128 v[100:103], v14 offset:2048
    v_mfma_f32_16x16x32_bf16 v[48:51], v[148:151], v[128:131], v[48:51]
    ds_read_b128 v[104:107], v14 offset:4096
    v_add_f32_dpp v172, v172, v172 row_shr:4 row_mask:0xf bank_mask:0xf
    v_mfma_f32_16x16x32_bf16 v[52:55], v[148:151], v[132:135], v[52:55]
    ds_read_b128 v[108:111], v14 offset:6144
    v_mfma_f32_16x16x32_bf16 v[56:59], v[148:151], v[136:139], v[56:59]
    ds_read_b64_tr_b16 v[116:117], v25 offset:0
    v_add_f32_dpp v172, v172, v172 row_shr:8 row_mask:0xf bank_mask:0xf
    v_mfma_f32_16x16x32_bf16 v[60:63], v[148:151], v[140:143], v[60:63]
    ds_read_b64_tr_b16 v[118:119], v25 offset:2048
    v_mfma_f32_16x16x32_bf16 v[64:67], v[152:155], v[128:131], v[64:67]
    ds_read_b64_tr_b16 v[120:121], v26 offset:0
    v_add_f32_dpp v172, v172, v172 row_bcast:15 row_mask:0xa bank_mask:0xf
    v_mfma_f32_16x16x32_bf16 v[68:71], v[152:155], v[132:135], v[68:71]
    ds_read_b64_tr_b16 v[122:123], v26 offset:2048
    v_mfma_f32_16x16x32_bf16 v[72:75], v[152:155], v[136:139], v[72:75]
    ds_read_b64_tr_b16 v[124:125], v27 offset:0
    v_add_f32_dpp v172, v172, v172 row_bcast:31 row_mask:0xc bank_mask:0xf
    v_mfma_f32_16x16x32_bf16 v[76:79], v[152:155], v[140:143], v[76:79]
    ds_read_b64_tr_b16 v[126:127], v27 offset:2048
    s_mov_b32 s62, 0x3fb8aa3b
    s_mov_b32 s63, 0x3fb8aa3b
    v_cvt_pk_bf16_f32 v172, v172, v172
    v_mfma_f32_16x16x32_bf16 v[80:83], v[156:159], v[128:131], v[80:83]
    v_lshlrev_b32 v172, 16, v172
    v_mul_f32 v172, s62, v172
    v_exp_f32 v172, -v172
    v_mfma_f32_16x16x32_bf16 v[84:87], v[156:159], v[132:135], v[84:87]
    v_mfma_f32_16x16x32_bf16 v[88:91], v[156:159], v[136:139], v[88:91]
    v_add_f32 v172, 1.0, v172
    v_rcp_f32 v172, v172
    v_mfma_f32_16x16x32_bf16 v[92:95], v[156:159], v[140:143], v[92:95]
    v_cvt_pk_bf16_f32 v172, v172, v172
    s_waitcnt lgkmcnt(9)
    v_mfma_f32_16x16x32_bf16 v[32:35], v[112:115], v[96:99], v[32:35]
    ds_read_b64_tr_b16 v[144:145], v24 offset:16384
    v_lshlrev_b32 v172, 16, v172
    s_waitcnt lgkmcnt(9)
    v_mfma_f32_16x16x32_bf16 v[36:39], v[112:115], v[100:103], v[36:39]
    ds_read_b64_tr_b16 v[146:147], v24 offset:18432
    v_sub_f32 v173, 1.0, v172
    s_waitcnt lgkmcnt(9)
    v_mfma_f32_16x16x32_bf16 v[40:43], v[112:115], v[104:107], v[40:43]
    ds_read_b128 v[128:131], v15 offset:0
    v_cvt_pk_bf16_f32 v173, v173, v173
    s_waitcnt lgkmcnt(9)
    v_mfma_f32_16x16x32_bf16 v[44:47], v[112:115], v[108:111], v[44:47]
    ds_read_b128 v[132:135], v15 offset:2048
    v_lshlrev_b32 v173, 16, v173
    s_waitcnt lgkmcnt(8)
    v_mfma_f32_16x16x32_bf16 v[48:51], v[116:119], v[96:99], v[48:51]
    ds_read_b128 v[136:139], v15 offset:4096
    s_lshl_b32 s92, s84, 3
    v_mfma_f32_16x16x32_bf16 v[52:55], v[116:119], v[100:103], v[52:55]
    ds_read_b128 v[140:143], v15 offset:6144
    s_add_u32 s92, s92, 22020096
    v_mfma_f32_16x16x32_bf16 v[56:59], v[116:119], v[104:107], v[56:59]
    ds_read_b64_tr_b16 v[148:149], v25 offset:16384
    v_mov_b32 v202, 0
    v_mfma_f32_16x16x32_bf16 v[60:63], v[116:119], v[108:111], v[60:63]
    ds_read_b64_tr_b16 v[150:151], v25 offset:18432
    s_mov_b32 exec_lo, 0
    s_mov_b32 exec_hi, 0x80000000
    buffer_store_dwordx2 v[172:173], v202, s[20:23], s92 offen sc1
    s_mov_b32 exec_lo, -1
    s_mov_b32 exec_hi, -1
    s_waitcnt lgkmcnt(10)
    v_mfma_f32_16x16x32_bf16 v[64:67], v[120:123], v[96:99], v[64:67]
    ds_read_b64_tr_b16 v[152:153], v26 offset:16384
    s_lshl_b32 s34, s41, 6
    v_mfma_f32_16x16x32_bf16 v[68:71], v[120:123], v[100:103], v[68:71]
    ds_read_b64_tr_b16 v[154:155], v26 offset:18432
    v_add_u32 v3, s34, v29
    v_mfma_f32_16x16x32_bf16 v[72:75], v[120:123], v[104:107], v[72:75]
    ds_read_b64_tr_b16 v[156:157], v27 offset:16384
    s_lshl_b32 s34, s42, 2
    v_mfma_f32_16x16x32_bf16 v[76:79], v[120:123], v[108:111], v[76:79]
    ds_read_b64_tr_b16 v[158:159], v27 offset:18432
    s_waitcnt lgkmcnt(12)
    v_mfma_f32_16x16x32_bf16 v[80:83], v[124:127], v[96:99], v[80:83]
    v_mfma_f32_16x16x32_bf16 v[84:87], v[124:127], v[100:103], v[84:87]
    v_mfma_f32_16x16x32_bf16 v[88:91], v[124:127], v[104:107], v[88:91]
    v_mfma_f32_16x16x32_bf16 v[92:95], v[124:127], v[108:111], v[92:95]
    s_waitcnt vmcnt(1) lgkmcnt(0)
    s_barrier
    v_mfma_f32_16x16x32_bf16 v[32:35], v[144:147], v[128:131], v[32:35]
    ds_read_b64_tr_b16 v[112:113], v16 offset:0
    s_add_u32 s35, s42, 0
    s_cmp_ge_u32 s35, 5
    s_cselect_b32 s58, s26, 0
    s_cmp_eq_u32 s58, 1
    s_cselect_b32 s36, 6, 5
    s_cselect_b32 s37, 48, 40
    s_cselect_b32 s39, 44, 48
    s_lshl_b32 s36, s36, 10
    s_lshl_b32 s39, s39, 10
    v_mfma_f32_16x16x32_bf16 v[36:39], v[144:147], v[132:135], v[36:39]
    ds_read_b64_tr_b16 v[114:115], v16 offset:2048
    s_add_u32 s35, s34, 0
    v_mfma_f32_16x16x32_bf16 v[40:43], v[144:147], v[136:139], v[40:43]
    ds_read_b128 v[96:99], v10 offset:0
    v_add_u32 v8, s35, v28
    v_mul_u32_u24 v9, 52, v8
    v_lshrrev_b32 v9, 8, v9
    v_mfma_f32_16x16x32_bf16 v[44:47], v[144:147], v[140:143], v[44:47]
    ds_read_b128 v[100:103], v10 offset:2048
    v_mul_u32_u24 v1, 5, v9
    v_sub_u32 v1, v8, v1
    v_lshlrev_b32 v1, 3, v1
    v_mfma_f32_16x16x32_bf16 v[48:51], v[148:151], v[128:131], v[48:51]
    ds_read_b128 v[104:107], v10 offset:4096
    v_mad_u32_u24 v1, v3, s37, v1
    v_mad_u32_u24 v1, v9, s36, v1
    v_add_u32 v4, s39, v1
    v_mfma_f32_16x16x32_bf16 v[52:55], v[148:151], v[132:135], v[52:55]
    ds_read_b128 v[108:111], v10 offset:6144
    s_add_u32 s35, s42, 4
    s_cmp_ge_u32 s35, 5
    s_cselect_b32 s59, s26, 0
    s_cmp_eq_u32 s59, 1
    s_cselect_b32 s36, 6, 5
    s_cselect_b32 s37, 48, 40
    s_cselect_b32 s39, 44, 48
    s_lshl_b32 s36, s36, 10
    s_lshl_b32 s39, s39, 10
    s_add_u32 s35, s34, 16
    v_add_u32 v8, s35, v28
    v_mfma_f32_16x16x32_bf16 v[56:59], v[148:151], v[136:139], v[56:59]
    ds_read_b64_tr_b16 v[116:117], v17 offset:0
    v_mul_u32_u24 v9, 52, v8
    v_lshrrev_b32 v9, 8, v9
    v_mul_u32_u24 v1, 5, v9
    v_mfma_f32_16x16x32_bf16 v[60:63], v[148:151], v[140:143], v[60:63]
    ds_read_b64_tr_b16 v[118:119], v17 offset:2048
    v_sub_u32 v1, v8, v1
    v_lshlrev_b32 v1, 3, v1
    v_mad_u32_u24 v1, v3, s37, v1
    v_mfma_f32_16x16x32_bf16 v[64:67], v[152:155], v[128:131], v[64:67]
    ds_read_b64_tr_b16 v[120:121], v18 offset:0
    v_mad_u32_u24 v1, v9, s36, v1
    v_add_u32 v5, s39, v1
    s_add_u32 s35, s42, 8
    s_cmp_ge_u32 s35, 5
    s_cselect_b32 s60, s26, 0
    s_cmp_eq_u32 s60, 1
    s_cselect_b32 s36, 6, 5
    s_cselect_b32 s37, 48, 40
    s_cselect_b32 s39, 44, 48
    s_lshl_b32 s36, s36, 10
    s_lshl_b32 s39, s39, 10
    v_mfma_f32_16x16x32_bf16 v[68:71], v[152:155], v[132:135], v[68:71]
    ds_read_b64_tr_b16 v[122:123], v18 offset:2048
    s_add_u32 s35, s34, 32
    v_add_u32 v8, s35, v28
    v_mul_u32_u24 v9, 52, v8
    v_mfma_f32_16x16x32_bf16 v[72:75], v[152:155], v[136:139], v[72:75]
    ds_read_b64_tr_b16 v[124:125], v19 offset:0
    v_lshrrev_b32 v9, 8, v9
    v_mul_u32_u24 v1, 5, v9
    v_sub_u32 v1, v8, v1
    v_mfma_f32_16x16x32_bf16 v[76:79], v[152:155], v[140:143], v[76:79]
    ds_read_b64_tr_b16 v[126:127], v19 offset:2048
    v_lshlrev_b32 v1, 3, v1
    v_mad_u32_u24 v1, v3, s37, v1
    v_mad_u32_u24 v1, v9, s36, v1
    v_mfma_f32_16x16x32_bf16 v[80:83], v[156:159], v[128:131], v[80:83]
    v_add_u32 v6, s39, v1
    s_add_u32 s35, s42, 12
    s_cmp_ge_u32 s35, 5
    s_cselect_b32 s61, s26, 0
    s_cmp_eq_u32 s61, 1
    s_cselect_b32 s36, 6, 5
    s_cselect_b32 s37, 48, 40
    s_cselect_b32 s39, 44, 48
    s_lshl_b32 s36, s36, 10
    s_lshl_b32 s39, s39, 10
    s_add_u32 s35, s34, 48
    v_mfma_f32_16x16x32_bf16 v[84:87], v[156:159], v[132:135], v[84:87]
    v_add_u32 v8, s35, v28
    v_mul_u32_u24 v9, 52, v8
    v_lshrrev_b32 v9, 8, v9
    v_mfma_f32_16x16x32_bf16 v[88:91], v[156:159], v[136:139], v[88:91]
    v_mul_u32_u24 v1, 5, v9
    v_sub_u32 v1, v8, v1
    v_lshlrev_b32 v1, 3, v1
    v_mfma_f32_16x16x32_bf16 v[92:95], v[156:159], v[140:143], v[92:95]
    v_mad_u32_u24 v1, v3, s37, v1
    v_mad_u32_u24 v1, v9, s36, v1
    v_add_u32 v7, s39, v1
    s_waitcnt lgkmcnt(9)
    v_mfma_f32_16x16x32_bf16 v[32:35], v[112:115], v[96:99], v[32:35]
    ds_read_b64_tr_b16 v[148:149], v17 offset:16384
    v_lshrrev_b32 v8, 7, v0
    s_waitcnt lgkmcnt(9)
    v_mfma_f32_16x16x32_bf16 v[36:39], v[112:115], v[100:103], v[36:39]
    ds_read_b64_tr_b16 v[150:151], v17 offset:18432
    v_and_b32 v9, 127, v0
    s_waitcnt lgkmcnt(9)
    v_mfma_f32_16x16x32_bf16 v[40:43], v[112:115], v[104:107], v[40:43]
    ds_read_b128 v[128:131], v11 offset:0
    v_mul_u32_u24 v9, 48, v9
    s_waitcnt lgkmcnt(9)
    v_mfma_f32_16x16x32_bf16 v[44:47], v[112:115], v[108:111], v[44:47]
    ds_read_b128 v[132:135], v11 offset:2048
    s_movk_i32 s36, 6144
    s_waitcnt lgkmcnt(8)
    v_mfma_f32_16x16x32_bf16 v[48:51], v[116:119], v[96:99], v[48:51]
    ds_read_b128 v[136:139], v11 offset:4096
    v_mad_u32_u24 v8, v8, s36, v9
    v_mfma_f32_16x16x32_bf16 v[52:55], v[116:119], v[100:103], v[52:55]
    ds_read_b128 v[140:143], v11 offset:6144
    v_mov_b32 v202, 0x3f80
    v_mfma_f32_16x16x32_bf16 v[56:59], v[116:119], v[104:107], v[56:59]
    ds_read_b64_tr_b16 v[152:153], v18 offset:16384
    v_mov_b32 v203, 0
    v_mfma_f32_16x16x32_bf16 v[60:63], v[116:119], v[108:111], v[60:63]
    ds_read_b64_tr_b16 v[154:155], v18 offset:18432
    v_mov_b32 v200, 0
    s_waitcnt lgkmcnt(10)
    v_mfma_f32_16x16x32_bf16 v[64:67], v[120:123], v[96:99], v[64:67]
    ds_read_b64_tr_b16 v[144:145], v16 offset:16384
    v_mov_b32 v201, 0
    v_mfma_f32_16x16x32_bf16 v[68:71], v[120:123], v[100:103], v[68:71]
    ds_read_b64_tr_b16 v[146:147], v16 offset:18432
    v_add_u32 v8, 69632, v8
    v_mfma_f32_16x16x32_bf16 v[72:75], v[120:123], v[104:107], v[72:75]
    ds_read_b64_tr_b16 v[156:157], v19 offset:16384
    s_cmp_eq_u32 s26, 0
    s_cbranch_scc1 K1_nopadE
        ds_write_b64 v8, v[200:201] offset:40
        ds_write_b64 v8, v[202:203] offset:24616
K1_nopadE:
    v_mfma_f32_16x16x32_bf16 v[76:79], v[120:123], v[108:111], v[76:79]
    ds_read_b64_tr_b16 v[158:159], v19 offset:18432
    s_mov_b32 s38, 0x358637bd
    s_mov_b32 s64, 0x3ea52b5c
    s_mov_b32 s65, 0x3ea52b5c
    s_waitcnt lgkmcnt(12)
    v_mfma_f32_16x16x32_bf16 v[80:83], v[124:127], v[96:99], v[80:83]
    s_mul_i32 s93, s33, 640
    v_add_u32 v30, s93, v204
    v_add_u32 v31, 49152, v30
    v_mfma_f32_16x16x32_bf16 v[84:87], v[124:127], v[100:103], v[84:87]
    s_mul_i32 s93, s25, 327680
    s_mul_i32 s35, s24, 5120
    s_add_u32 s93, s93, s35
    v_mfma_f32_16x16x32_bf16 v[88:91], v[124:127], v[104:107], v[88:91]
    s_mul_i32 s35, s26, 9437184
    s_add_u32 s93, s93, s35
    v_mfma_f32_16x16x32_bf16 v[92:95], v[124:127], v[108:111], v[92:95]
    s_waitcnt lgkmcnt(9)
    v_mfma_f32_16x16x32_bf16 v[48:51], v[148:151], v[128:131], v[48:51]
    s_waitcnt lgkmcnt(8)
    v_mfma_f32_16x16x32_bf16 v[52:55], v[148:151], v[132:135], v[52:55]
    s_waitcnt lgkmcnt(7)
    v_mfma_f32_16x16x32_bf16 v[56:59], v[148:151], v[136:139], v[56:59]
    s_waitcnt lgkmcnt(6)
    v_mfma_f32_16x16x32_bf16 v[60:63], v[148:151], v[140:143], v[60:63]
    s_waitcnt lgkmcnt(4)
    v_mfma_f32_16x16x32_bf16 v[64:67], v[152:155], v[128:131], v[64:67]
    v_mfma_f32_16x16x32_bf16 v[68:71], v[152:155], v[132:135], v[68:71]
    v_mfma_f32_16x16x32_bf16 v[72:75], v[152:155], v[136:139], v[72:75]
    v_mfma_f32_16x16x32_bf16 v[76:79], v[152:155], v[140:143], v[76:79]
    s_cmp_eq_u32 s53, 0
    s_cbranch_scc1 K1_nophi1E
    v_pk_mul_f32 v[160:161], v[48:49], s[62:63]
    v_pk_mul_f32 v[162:163], v[50:51], s[62:63]
    v_pk_mul_f32 v[164:165], v[52:53], s[62:63]
    v_pk_mul_f32 v[166:167], v[54:55], s[62:63]
    v_pk_mul_f32 v[168:169], v[56:57], s[62:63]
    v_pk_mul_f32 v[170:171], v[58:59], s[62:63]
    v_pk_mul_f32 v[172:173], v[60:61], s[62:63]
    v_pk_mul_f32 v[174:175], v[62:63], s[62:63]
    v_exp_f32 v160, v160 clamp
    v_exp_f32 v161, v161 clamp
    v_exp_f32 v162, v162 clamp
    v_exp_f32 v163, v163 clamp
    v_exp_f32 v164, v164 clamp
    v_exp_f32 v165, v165 clamp
    v_exp_f32 v166, v166 clamp
    v_exp_f32 v167, v167 clamp
    v_exp_f32 v168, v168 clamp
    v_exp_f32 v169, v169 clamp
    v_exp_f32 v170, v170 clamp
    v_exp_f32 v171, v171 clamp
    v_exp_f32 v172, v172 clamp
    v_exp_f32 v173, v173 clamp
    v_exp_f32 v174, v174 clamp
    v_exp_f32 v175, v175 clamp
    v_max_f32 v48, s38, v48
    v_max_f32 v49, s38, v49
    v_max_f32 v50, s38, v50
    v_max_f32 v51, s38, v51
    v_max_f32 v52, s38, v52
    v_max_f32 v53, s38, v53
    v_max_f32 v54, s38, v54
    v_max_f32 v55, s38, v55
    v_max_f32 v56, s38, v56
    v_max_f32 v57, s38, v57
    v_max_f32 v58, s38, v58
    v_max_f32 v59, s38, v59
    v_max_f32 v60, s38, v60
    v_max_f32 v61, s38, v61
    v_max_f32 v62, s38, v62
    v_max_f32 v63, s38, v63
    v_pk_add_f32 v[48:49], v[48:49], v[160:161]
    v_pk_add_f32 v[50:51], v[50:51], v[162:163]
    v_pk_add_f32 v[52:53], v[52:53], v[164:165]
    v_pk_add_f32 v[54:55], v[54:55], v[166:167]
    v_pk_add_f32 v[56:57], v[56:57], v[168:169]
    v_pk_add_f32 v[58:59], v[58:59], v[170:171]
    v_pk_add_f32 v[60:61], v[60:61], v[172:173]
    v_pk_add_f32 v[62:63], v[62:63], v[174:175]
K1_nophi1E:
    s_cmp_eq_u32 s49, 0
    s_cbranch_scc1 K1_noscl1E
    v_pk_mul_f32 v[48:49], v[48:49], s[64:65]
    v_pk_mul_f32 v[50:51], v[50:51], s[64:65]
    v_pk_mul_f32 v[52:53], v[52:53], s[64:65]
    v_pk_mul_f32 v[54:55], v[54:55], s[64:65]
    v_pk_mul_f32 v[56:57], v[56:57], s[64:65]
    v_pk_mul_f32 v[58:59], v[58:59], s[64:65]
    v_pk_mul_f32 v[60:61], v[60:61], s[64:65]
    v_pk_mul_f32 v[62:63], v[62:63], s[64:65]
K1_noscl1E:
    v_cvt_pk_bf16_f32 v104, v48, v49
    v_cvt_pk_bf16_f32 v105, v50, v51
    v_cvt_pk_bf16_f32 v106, v52, v53
    v_cvt_pk_bf16_f32 v107, v54, v55
    v_cvt_pk_bf16_f32 v108, v56, v57
    v_cvt_pk_bf16_f32 v109, v58, v59
    v_cvt_pk_bf16_f32 v110, v60, v61
    v_cvt_pk_bf16_f32 v111, v62, v63
    s_cmp_eq_u32 s59, 0
    s_cbranch_scc1 K1_dn1E
    ds_write_b64 v5, v[104:105] offset:0
    ds_write_b64 v5, v[106:107] offset:768
    ds_write_b64 v5, v[108:109] offset:1536
    ds_write_b64 v5, v[110:111] offset:2304
    s_branch K1_wr1E
K1_dn1E:
        ds_write_b64 v5, v[104:105] offset:0
        ds_write_b64 v5, v[106:107] offset:640
        ds_write_b64 v5, v[108:109] offset:1280
        ds_write_b64 v5, v[110:111] offset:1920
K1_wr1E:
    s_waitcnt lgkmcnt(6)
    v_mfma_f32_16x16x32_bf16 v[32:35], v[144:147], v[128:131], v[32:35]
    v_mfma_f32_16x16x32_bf16 v[36:39], v[144:147], v[132:135], v[36:39]
    v_mfma_f32_16x16x32_bf16 v[40:43], v[144:147], v[136:139], v[40:43]
    v_mfma_f32_16x16x32_bf16 v[44:47], v[144:147], v[140:143], v[44:47]
    s_cmp_eq_u32 s54, 0
    s_cbranch_scc1 K1_nophi2E
    v_pk_mul_f32 v[160:161], v[64:65], s[62:63]
    v_pk_mul_f32 v[162:163], v[66:67], s[62:63]
    v_pk_mul_f32 v[164:165], v[68:69], s[62:63]
    v_pk_mul_f32 v[166:167], v[70:71], s[62:63]
    v_pk_mul_f32 v[168:169], v[72:73], s[62:63]
    v_pk_mul_f32 v[170:171], v[74:75], s[62:63]
    v_pk_mul_f32 v[172:173], v[76:77], s[62:63]
    v_pk_mul_f32 v[174:175], v[78:79], s[62:63]
    v_exp_f32 v160, v160 clamp
    v_exp_f32 v161, v161 clamp
    v_exp_f32 v162, v162 clamp
    v_exp_f32 v163, v163 clamp
    v_exp_f32 v164, v164 clamp
    v_exp_f32 v165, v165 clamp
    v_exp_f32 v166, v166 clamp
    v_exp_f32 v167, v167 clamp
    v_exp_f32 v168, v168 clamp
    v_exp_f32 v169, v169 clamp
    v_exp_f32 v170, v170 clamp
    v_exp_f32 v171, v171 clamp
    v_exp_f32 v172, v172 clamp
    v_exp_f32 v173, v173 clamp
    v_exp_f32 v174, v174 clamp
    v_exp_f32 v175, v175 clamp
    v_max_f32 v64, s38, v64
    v_max_f32 v65, s38, v65
    v_max_f32 v66, s38, v66
    v_max_f32 v67, s38, v67
    v_max_f32 v68, s38, v68
    v_max_f32 v69, s38, v69
    v_max_f32 v70, s38, v70
    v_max_f32 v71, s38, v71
    v_max_f32 v72, s38, v72
    v_max_f32 v73, s38, v73
    v_max_f32 v74, s38, v74
    v_max_f32 v75, s38, v75
    v_max_f32 v76, s38, v76
    v_max_f32 v77, s38, v77
    v_max_f32 v78, s38, v78
    v_max_f32 v79, s38, v79
    v_pk_add_f32 v[64:65], v[64:65], v[160:161]
    v_pk_add_f32 v[66:67], v[66:67], v[162:163]
    v_pk_add_f32 v[68:69], v[68:69], v[164:165]
    v_pk_add_f32 v[70:71], v[70:71], v[166:167]
    v_pk_add_f32 v[72:73], v[72:73], v[168:169]
    v_pk_add_f32 v[74:75], v[74:75], v[170:171]
    v_pk_add_f32 v[76:77], v[76:77], v[172:173]
    v_pk_add_f32 v[78:79], v[78:79], v[174:175]
K1_nophi2E:
    s_cmp_eq_u32 s50, 0
    s_cbranch_scc1 K1_noscl2E
    v_pk_mul_f32 v[64:65], v[64:65], s[64:65]
    v_pk_mul_f32 v[66:67], v[66:67], s[64:65]
    v_pk_mul_f32 v[68:69], v[68:69], s[64:65]
    v_pk_mul_f32 v[70:71], v[70:71], s[64:65]
    v_pk_mul_f32 v[72:73], v[72:73], s[64:65]
    v_pk_mul_f32 v[74:75], v[74:75], s[64:65]
    v_pk_mul_f32 v[76:77], v[76:77], s[64:65]
    v_pk_mul_f32 v[78:79], v[78:79], s[64:65]
K1_noscl2E:
    v_cvt_pk_bf16_f32 v112, v64, v65
    v_cvt_pk_bf16_f32 v113, v66, v67
    v_cvt_pk_bf16_f32 v114, v68, v69
    v_cvt_pk_bf16_f32 v115, v70, v71
    v_cvt_pk_bf16_f32 v116, v72, v73
    v_cvt_pk_bf16_f32 v117, v74, v75
    v_cvt_pk_bf16_f32 v118, v76, v77
    v_cvt_pk_bf16_f32 v119, v78, v79
    s_cmp_eq_u32 s60, 0
    s_cbranch_scc1 K1_dn2E
    ds_write_b64 v6, v[112:113] offset:0
    ds_write_b64 v6, v[114:115] offset:768
    ds_write_b64 v6, v[116:117] offset:1536
    ds_write_b64 v6, v[118:119] offset:2304
    s_branch K1_wr2E
K1_dn2E:
        ds_write_b64 v6, v[112:113] offset:0
        ds_write_b64 v6, v[114:115] offset:640
        ds_write_b64 v6, v[116:117] offset:1280
        ds_write_b64 v6, v[118:119] offset:1920
K1_wr2E:
    s_waitcnt lgkmcnt(8)
    v_mfma_f32_16x16x32_bf16 v[80:83], v[156:159], v[128:131], v[80:83]
    v_mfma_f32_16x16x32_bf16 v[84:87], v[156:159], v[132:135], v[84:87]
    v_mfma_f32_16x16x32_bf16 v[88:91], v[156:159], v[136:139], v[88:91]
    v_mfma_f32_16x16x32_bf16 v[92:95], v[156:159], v[140:143], v[92:95]
    s_cmp_eq_u32 s48, 0
    s_cbranch_scc1 K1_noscl0E
    v_pk_mul_f32 v[32:33], v[32:33], s[64:65]
    v_pk_mul_f32 v[34:35], v[34:35], s[64:65]
    v_pk_mul_f32 v[36:37], v[36:37], s[64:65]
    v_pk_mul_f32 v[38:39], v[38:39], s[64:65]
    v_pk_mul_f32 v[40:41], v[40:41], s[64:65]
    v_pk_mul_f32 v[42:43], v[42:43], s[64:65]
    v_pk_mul_f32 v[44:45], v[44:45], s[64:65]
    v_pk_mul_f32 v[46:47], v[46:47], s[64:65]
K1_noscl0E:
    v_cvt_pk_bf16_f32 v96, v32, v33
    v_cvt_pk_bf16_f32 v97, v34, v35
    v_cvt_pk_bf16_f32 v98, v36, v37
    v_cvt_pk_bf16_f32 v99, v38, v39
    v_cvt_pk_bf16_f32 v100, v40, v41
    v_cvt_pk_bf16_f32 v101, v42, v43
    v_cvt_pk_bf16_f32 v102, v44, v45
    v_cvt_pk_bf16_f32 v103, v46, v47
    ds_write_b64 v4, v[96:97] offset:0
    ds_write_b64 v4, v[98:99] offset:640
    ds_write_b64 v4, v[100:101] offset:1280
    ds_write_b64 v4, v[102:103] offset:1920
    s_cmp_eq_u32 s51, 0
    s_cbranch_scc1 K1_noscl3E
    v_pk_mul_f32 v[80:81], v[80:81], s[64:65]
    v_pk_mul_f32 v[82:83], v[82:83], s[64:65]
    v_pk_mul_f32 v[84:85], v[84:85], s[64:65]
    v_pk_mul_f32 v[86:87], v[86:87], s[64:65]
    v_pk_mul_f32 v[88:89], v[88:89], s[64:65]
    v_pk_mul_f32 v[90:91], v[90:91], s[64:65]
    v_pk_mul_f32 v[92:93], v[92:93], s[64:65]
    v_pk_mul_f32 v[94:95], v[94:95], s[64:65]
K1_noscl3E:
    v_cvt_pk_bf16_f32 v120, v80, v81
    v_cvt_pk_bf16_f32 v121, v82, v83
    v_cvt_pk_bf16_f32 v122, v84, v85
    v_cvt_pk_bf16_f32 v123, v86, v87
    v_cvt_pk_bf16_f32 v124, v88, v89
    v_cvt_pk_bf16_f32 v125, v90, v91
    v_cvt_pk_bf16_f32 v126, v92, v93
    v_cvt_pk_bf16_f32 v127, v94, v95
    s_cmp_eq_u32 s61, 0
    s_cbranch_scc1 K1_dn3E
    ds_write_b64 v7, v[120:121] offset:0
    ds_write_b64 v7, v[122:123] offset:768
    ds_write_b64 v7, v[124:125] offset:1536
    ds_write_b64 v7, v[126:127] offset:2304
    s_branch K1_wr3E
K1_dn3E:
        ds_write_b64 v7, v[120:121] offset:0
        ds_write_b64 v7, v[122:123] offset:640
        ds_write_b64 v7, v[124:125] offset:1280
        ds_write_b64 v7, v[126:127] offset:1920
K1_wr3E:
    s_waitcnt lgkmcnt(0)
    s_barrier
    s_mov_b32 exec_hi, 0xff
    ds_read_b128 v[32:35], v31 offset:0
    ds_read_b128 v[36:39], v31 offset:5120
    ds_read_b128 v[40:43], v31 offset:10240
    ds_read_b128 v[44:47], v31 offset:15360
    s_cmp_eq_u32 s26, 0
    s_cbranch_scc0 K1_bpath
    ds_read_b128 v[48:51], v31 offset:20480
    ds_read_b128 v[52:55], v31 offset:25600
    ds_read_b128 v[56:59], v31 offset:30720
    ds_read_b128 v[60:63], v31 offset:35840
    ds_read_b128 v[64:67], v31 offset:40960
    ds_read_b128 v[68:71], v31 offset:46080
    ds_read_b128 v[72:75], v31 offset:51200
    ds_read_b128 v[76:79], v31 offset:56320
    s_mul_i32 s91, s25, 12
    s_mul_i32 s90, s24, 5120
    s_add_u32 s36, s91, 0
    s_lshr_b32 s37, s36, 5
    s_mul_i32 s37, s37, 0x80000
    s_mul_i32 s36, s36, 81920
    s_add_u32 s35, s36, s37
    s_add_u32 s35, s35, s90
    s_waitcnt lgkmcnt(11)
    buffer_store_dwordx4 v[32:35], v30, s[20:23], s35 offen sc1
    s_add_u32 s36, s91, 1
    s_lshr_b32 s37, s36, 5
    s_mul_i32 s37, s37, 0x80000
    s_mul_i32 s36, s36, 81920
    s_add_u32 s35, s36, s37
    s_add_u32 s35, s35, s90
    s_waitcnt lgkmcnt(10)
    buffer_store_dwordx4 v[36:39], v30, s[20:23], s35 offen sc1
    s_add_u32 s36, s91, 2
    s_lshr_b32 s37, s36, 5
    s_mul_i32 s37, s37, 0x80000
    s_mul_i32 s36, s36, 81920
    s_add_u32 s35, s36, s37
    s_add_u32 s35, s35, s90
    s_waitcnt lgkmcnt(9)
    buffer_store_dwordx4 v[40:43], v30, s[20:23], s35 offen sc1
    s_add_u32 s36, s91, 3
    s_lshr_b32 s37, s36, 5
    s_mul_i32 s37, s37, 0x80000
    s_mul_i32 s36, s36, 81920
    s_add_u32 s35, s36, s37
    s_add_u32 s35, s35, s90
    s_waitcnt lgkmcnt(8)
    buffer_store_dwordx4 v[44:47], v30, s[20:23], s35 offen sc1
    s_add_u32 s36, s91, 4
    s_lshr_b32 s37, s36, 5
    s_mul_i32 s37, s37, 0x80000
    s_mul_i32 s36, s36, 81920
    s_add_u32 s35, s36, s37
    s_add_u32 s35, s35, s90
    s_waitcnt lgkmcnt(7)
    buffer_store_dwordx4 v[48:51], v30, s[20:23], s35 offen sc1
    s_add_u32 s36, s91, 5
    s_lshr_b32 s37, s36, 5
    s_mul_i32 s37, s37, 0x80000
    s_mul_i32 s36, s36, 81920
    s_add_u32 s35, s36, s37
    s_add_u32 s35, s35, s90
    s_waitcnt lgkmcnt(6)
    buffer_store_dwordx4 v[52:55], v30, s[20:23], s35 offen sc1
    s_add_u32 s36, s91, 6
    s_lshr_b32 s37, s36, 5
    s_mul_i32 s37, s37, 0x80000
    s_mul_i32 s36, s36, 81920
    s_add_u32 s35, s36, s37
    s_add_u32 s35, s35, s90
    s_waitcnt lgkmcnt(5)
    buffer_store_dwordx4 v[56:59], v30, s[20:23], s35 offen sc1
    s_add_u32 s36, s91, 7
    s_lshr_b32 s37, s36, 5
    s_mul_i32 s37, s37, 0x80000
    s_mul_i32 s36, s36, 81920
    s_add_u32 s35, s36, s37
    s_add_u32 s35, s35, s90
    s_waitcnt lgkmcnt(4)
    buffer_store_dwordx4 v[60:63], v30, s[20:23], s35 offen sc1
    s_add_u32 s36, s91, 8
    s_lshr_b32 s37, s36, 5
    s_mul_i32 s37, s37, 0x80000
    s_mul_i32 s36, s36, 81920
    s_add_u32 s35, s36, s37
    s_add_u32 s35, s35, s90
    s_waitcnt lgkmcnt(3)
    buffer_store_dwordx4 v[64:67], v30, s[20:23], s35 offen sc1
    s_add_u32 s36, s91, 9
    s_lshr_b32 s37, s36, 5
    s_mul_i32 s37, s37, 0x80000
    s_mul_i32 s36, s36, 81920
    s_add_u32 s35, s36, s37
    s_add_u32 s35, s35, s90
    s_waitcnt lgkmcnt(2)
    buffer_store_dwordx4 v[68:71], v30, s[20:23], s35 offen sc1
    s_add_u32 s36, s91, 10
    s_lshr_b32 s37, s36, 5
    s_mul_i32 s37, s37, 0x80000
    s_mul_i32 s36, s36, 81920
    s_add_u32 s35, s36, s37
    s_add_u32 s35, s35, s90
    s_waitcnt lgkmcnt(1)
    buffer_store_dwordx4 v[72:75], v30, s[20:23], s35 offen sc1
    s_add_u32 s36, s91, 11
    s_lshr_b32 s37, s36, 5
    s_mul_i32 s37, s37, 0x80000
    s_mul_i32 s36, s36, 81920
    s_add_u32 s35, s36, s37
    s_add_u32 s35, s35, s90
    s_waitcnt lgkmcnt(0)
    buffer_store_dwordx4 v[76:79], v30, s[20:23], s35 offen sc1
    s_mov_b32 exec_hi, -1
    s_mov_b32 s93, 0x40000000
    s_mov_b32 s92, 0x40000000
    s_branch P1_end
K1_bpath:
    s_waitcnt lgkmcnt(0)
    s_add_u32 s35, s93, 0
    buffer_store_dwordx4 v[32:35], v30, s[20:23], s35 offen sc1
    s_add_u32 s35, s93, 81920
    buffer_store_dwordx4 v[36:39], v30, s[20:23], s35 offen sc1
    s_add_u32 s35, s93, 163840
    buffer_store_dwordx4 v[40:43], v30, s[20:23], s35 offen sc1
    s_add_u32 s35, s93, 245760
    buffer_store_dwordx4 v[44:47], v30, s[20:23], s35 offen sc1
    s_mov_b32 exec_hi, -1
    s_mov_b32 s92, 0x40000000
    s_cmp_gt_u32 s33, 3
    s_cbranch_scc1 P1_end
    v_lshrrev_b32 v7, 5, v2
    v_bfe_u32 v6, v2, 2, 2
    v_lshl_add_u32 v5, v7, 3, v6
    v_mul_u32_u24 v5, 48, v5
    v_bfe_u32 v6, v2, 4, 1
    v_lshl_add_u32 v5, v6, 5, v5
    v_and_b32 v6, 3, v2
    v_lshl_add_u32 v5, v6, 3, v5
    s_mul_i32 s35, s33, 6144
    s_add_u32 s35, s35, 69632
    v_add_u32 v5, s35, v5
    ds_read_b64_tr_b16 v[112:113], v5 offset:0
    ds_read_b64_tr_b16 v[114:115], v5 offset:192
    ds_read_b64_tr_b16 v[116:117], v5 offset:24576
    ds_read_b64_tr_b16 v[118:119], v5 offset:24768
    ds_read_b64_tr_b16 v[120:121], v5 offset:768
    ds_read_b64_tr_b16 v[122:123], v5 offset:960
    ds_read_b64_tr_b16 v[124:125], v5 offset:25344
    ds_read_b64_tr_b16 v[126:127], v5 offset:25536
    ds_read_b64_tr_b16 v[128:129], v5 offset:1536
    ds_read_b64_tr_b16 v[130:131], v5 offset:1728
    ds_read_b64_tr_b16 v[132:133], v5 offset:26112
    ds_read_b64_tr_b16 v[134:135], v5 offset:26304
    s_waitcnt lgkmcnt(8)
    v_mfma_f32_32x32x16_bf16 v[96:111], v[112:115], v[116:119], 0
    ds_read_b64_tr_b16 v[136:137], v5 offset:2304
    ds_read_b64_tr_b16 v[138:139], v5 offset:2496
    ds_read_b64_tr_b16 v[140:141], v5 offset:26880
    ds_read_b64_tr_b16 v[142:143], v5 offset:27072
    s_waitcnt lgkmcnt(8)
    v_mfma_f32_32x32x16_bf16 v[96:111], v[120:123], v[124:127], v[96:111]
    ds_read_b64_tr_b16 v[144:145], v5 offset:3072
    ds_read_b64_tr_b16 v[146:147], v5 offset:3264
    ds_read_b64_tr_b16 v[148:149], v5 offset:27648
    ds_read_b64_tr_b16 v[150:151], v5 offset:27840
    s_waitcnt lgkmcnt(8)
    v_mfma_f32_32x32x16_bf16 v[96:111], v[128:131], v[132:135], v[96:111]
    ds_read_b64_tr_b16 v[152:153], v5 offset:3840
    ds_read_b64_tr_b16 v[154:155], v5 offset:4032
    ds_read_b64_tr_b16 v[156:157], v5 offset:28416
    ds_read_b64_tr_b16 v[158:159], v5 offset:28608
    s_waitcnt lgkmcnt(8)
    v_mfma_f32_32x32x16_bf16 v[96:111], v[136:139], v[140:143], v[96:111]
    ds_read_b64_tr_b16 v[160:161], v5 offset:4608
    ds_read_b64_tr_b16 v[162:163], v5 offset:4800
    ds_read_b64_tr_b16 v[164:165], v5 offset:29184
    ds_read_b64_tr_b16 v[166:167], v5 offset:29376
    s_waitcnt lgkmcnt(8)
    v_mfma_f32_32x32x16_bf16 v[96:111], v[144:147], v[148:151], v[96:111]
    ds_read_b64_tr_b16 v[168:169], v5 offset:5376
    ds_read_b64_tr_b16 v[170:171], v5 offset:5568
    ds_read_b64_tr_b16 v[172:173], v5 offset:29952
    ds_read_b64_tr_b16 v[174:175], v5 offset:30144
    s_waitcnt lgkmcnt(8)
    v_mfma_f32_32x32x16_bf16 v[96:111], v[152:155], v[156:159], v[96:111]
    s_waitcnt lgkmcnt(4)
    v_mfma_f32_32x32x16_bf16 v[96:111], v[160:163], v[164:167], v[96:111]
    s_waitcnt lgkmcnt(0)
    v_mfma_f32_32x32x16_bf16 v[96:111], v[168:171], v[172:175], v[96:111]
    s_lshl_b32 s34, s25, 2
    s_add_u32 s34, s34, s33
    s_lshl_b32 s34, s34, 4
    s_add_u32 s34, s34, s24
    s_mul_i32 s34, s34, 2304
    s_add_u32 s34, s34, 12582912
    v_and_b32 v3, 31, v2
    v_lshlrev_b32 v3, 4, v3
    v_mul_u32_u24 v7, 384, v7
    v_add_u32 v3, v3, v7
    s_mov_b32 exec_lo, 0xffffff
    s_mov_b32 exec_hi, 0xffffff
    buffer_store_dwordx4 v[96:99], v3, s[20:23], s34 offen offset:0 sc1
    buffer_store_dwordx4 v[100:103], v3, s[20:23], s34 offen offset:768 sc1
    buffer_store_dwordx4 v[104:107], v3, s[20:23], s34 offen offset:1536 sc1
    s_mov_b32 exec_lo, -1
    s_mov_b32 exec_hi, -1
P1_end:
    s_mov_b32 s70, 22151168
    s_lshl_b32 s72, s2, 7
    s_add_u32 s72, s72, s70
    s_mov_b32 s75, s26
    s_waitcnt vmcnt(0)
    s_barrier
S1_nodrain:
    s_cmp_lg_u32 s33, 0
    s_cbranch_scc1 S1_pubdone
    v_readfirstlane_b32 s94, v208
    s_mov_b32 s95, 200000
S1_tag:
    s_cmp_lg_u32 s94, 0
    s_cbranch_scc1 S1_havetag
    s_sub_u32 s95, s95, 1
    s_cmp_eq_u32 s95, 0
    s_cbranch_scc1 S1_havetag
    s_sleep 1
    v_mov_b32 v232, 0
        global_load_dword v208, v232, s[96:97] sc1
        s_waitcnt vmcnt(0)
    v_readfirstlane_b32 s94, v208
    s_branch S1_tag
S1_havetag:
    v_mov_b32 v232, s94
    v_mov_b32 v233, 0
    v_mov_b32 v234, 161792
    s_mov_b32 exec_lo, 1
    s_mov_b32 exec_hi, 0
    s_cmp_lg_u32 s75, 0
    s_mov_b32 s76, s72
        buffer_store_dword v232, v233, s[20:23], s76 offen sc1
        ds_write_b32 v234, v233
    s_mov_b32 exec_lo, -1
    s_mov_b32 exec_hi, -1
S1_pubdone:
    s_and_b32 s36, s2, 7
    s_lshr_b32 s37, s2, 3
    s_and_b32 s38, s36, 3
    s_lshl_b32 s38, s38, 3
    s_and_b32 s39, s37, 7
    s_add_u32 s32, s38, s39
    s_lshr_b32 s38, s36, 2
    s_lshl_b32 s38, s38, 2
    s_lshr_b32 s39, s37, 3
    s_add_u32 s31, s38, s39
    v_lshlrev_b32 v3, 4, v2
    v_and_b32 v4, 31, v2
    v_lshrrev_b32 v5, 5, v2
    s_lshl_b32 s35, s32, 11
    s_lshl_b32 s36, s31, 8
    s_add_u32 s35, s35, s36
    s_mul_i32 s40, s33, 3072
    v_add_u32 v216, s40, v3
    s_mul_i32 s41, s35, 40
    s_mul_i32 s36, s33, 2560
    s_add_u32 s36, s36, s41
    s_add_u32 s42, s36, 3135488
    s_add_u32 s43, s36, 6281216
    v_add_u32 v12, 0, v2
    v_mul_u32_u24 v13, 171, v12
    v_lshrrev_b32 v13, 9, v13
    v_mul_u32_u24 v14, 3, v13
    v_sub_u32 v14, v12, v14
    v_lshlrev_b32 v14, 4, v14
    v_mad_u32_u24 v249, v13, 40, v14
    v_add_u32 v12, 64, v2
    v_mul_u32_u24 v13, 171, v12
    v_lshrrev_b32 v13, 9, v13
    v_mul_u32_u24 v14, 3, v13
    v_sub_u32 v14, v12, v14
    v_lshlrev_b32 v14, 4, v14
    v_mad_u32_u24 v250, v13, 40, v14
    v_add_u32 v12, 128, v2
    v_mul_u32_u24 v13, 171, v12
    v_lshrrev_b32 v13, 9, v13
    v_mul_u32_u24 v14, 3, v13
    v_sub_u32 v14, v12, v14
    v_lshlrev_b32 v14, 4, v14
    v_mad_u32_u24 v251, v13, 40, v14
    s_lshr_b32 s55, s33, 2
    s_or_b32 s55, s55, s31
    s_cmp_eq_u32 s55, 0
    s_cselect_b32 s42, 0x40000000, s42
    s_cselect_b32 s43, 0x40000000, s43
    s_lshl_b32 s36, s33, 5
    v_add_u32 v12, s36, v4
    v_mul_u32_u24 v12, 40, v12
    v_lshl_add_u32 v6, v5, 4, v12
    v_lshl_add_u32 v7, v5, 3, v12
    s_add_u32 s44, s41, 9437184
    v_mov_b32 v20, 0
    v_mov_b32 v21, 0
    v_mov_b32 v22, 0
    v_mov_b32 v23, 0
    s_mov_b32 exec_hi, 0
    v_mov_b32 v22, 0x3f80
    s_mov_b32 exec_hi, -1
    s_cmp_ge_u32 s33, 3
    s_cselect_b32 s37, 8, 0
    s_cselect_b32 s38, 3, 0
    s_sub_u32 s38, s33, s38
    s_lshl_b32 s66, s32, 4
    s_add_u32 s66, s66, s37
    s_mul_i32 s66, s66, 2304
    s_mul_i32 s38, s38, 768
    s_add_u32 s66, s66, s38
    s_add_u32 s66, s66, 12582912
    s_cmp_ge_u32 s33, 6
    s_cselect_b32 s66, 0x40000000, s66
    v_mul_u32_u24 v12, 384, v5
    v_min_u32 v13, 23, v4
    v_lshl_add_u32 v217, v13, 4, v12
    v_add_u32 v217, 49216, v217
    s_lshr_b32 s46, s2, 3
    s_lshl_b32 s46, s46, 3
    s_add_u32 s46, s46, s33
    s_mul_i32 s46, s46, 6400
    s_add_u32 s46, s46, 19922944
    v_min_u32 v218, 49, v2
    v_lshlrev_b32 v218, 7, v218
    s_mul_i32 s36, s33, 1536
    v_mul_u32_u24 v12, 48, v4
    v_add_u32 v12, s36, v12
    v_lshl_add_u32 v8, v5, 4, v12
    v_add_u32 v9, 32, v12
    v_bfe_u32 v12, v2, 2, 2
    v_lshl_add_u32 v12, v5, 2, v12
    v_mul_u32_u24 v12, 48, v12
    v_bfe_u32 v13, v2, 4, 1
    v_lshl_add_u32 v12, v13, 5, v12
    v_and_b32 v14, 3, v2
    v_lshl_add_u32 v12, v14, 3, v12
    s_add_u32 s36, s36, 24576
    v_add_u32 v10, s36, v12
    s_lshl_b32 s36, s31, 4
    s_lshl_b32 s37, s33, 1
    s_add_u32 s36, s36, s37
    s_mul_i32 s36, s36, 40960
    s_add_u32 s36, s36, 14680064
    s_lshl_b32 s39, s32, 9
    s_add_u32 s68, s39, s36
    s_lshl_b32 s37, s32, 7
    s_add_u32 s37, s37, 16384
    s_add_u32 s69, s37, s36
    s_mov_b32 s38, 40960
    v_and_b32 v14, 15, v2
    v_mul_lo_u32 v13, v13, s38
    v_lshl_add_u32 v220, v14, 3, v13
    v_lshl_add_u32 v13, v14, 4, v13
    v_lshl_add_u32 v219, v5, 8, v13
    v_lshlrev_b32 v12, 2, v5
    v_sub_u32 v12, v4, v12
    v_mov_b32 v13, 0xf149f2ca
    v_cmp_le_i32 s[56:57], 0, v12
    v_cmp_le_i32 s[58:59], 1, v12
    v_cmp_le_i32 s[60:61], 2, v12
    v_cmp_le_i32 s[62:63], 3, v12
    v_cndmask_b32 v48, v13, 0, s[56:57]
    v_cndmask_b32 v32, 0, v13, s[56:57]
    v_cndmask_b32 v49, v13, 0, s[58:59]
    v_cndmask_b32 v33, 0, v13, s[58:59]
    v_cndmask_b32 v50, v13, 0, s[60:61]
    v_cndmask_b32 v34, 0, v13, s[60:61]
    v_cndmask_b32 v51, v13, 0, s[62:63]
    v_cndmask_b32 v35, 0, v13, s[62:63]
    v_cmp_le_i32 s[56:57], 8, v12
    v_cmp_le_i32 s[58:59], 9, v12
    v_cmp_le_i32 s[60:61], 10, v12
    v_cmp_le_i32 s[62:63], 11, v12
    v_cndmask_b32 v52, v13, 0, s[56:57]
    v_cndmask_b32 v36, 0, v13, s[56:57]
    v_cndmask_b32 v53, v13, 0, s[58:59]
    v_cndmask_b32 v37, 0, v13, s[58:59]
    v_cndmask_b32 v54, v13, 0, s[60:61]
    v_cndmask_b32 v38, 0, v13, s[60:61]
    v_cndmask_b32 v55, v13, 0, s[62:63]
    v_cndmask_b32 v39, 0, v13, s[62:63]
    v_cmp_le_i32 s[56:57], 16, v12
    v_cmp_le_i32 s[58:59], 17, v12
    v_cmp_le_i32 s[60:61], 18, v12
    v_cmp_le_i32 s[62:63], 19, v12
    v_cndmask_b32 v56, v13, 0, s[56:57]
    v_cndmask_b32 v40, 0, v13, s[56:57]
    v_cndmask_b32 v57, v13, 0, s[58:59]
    v_cndmask_b32 v41, 0, v13, s[58:59]
    v_cndmask_b32 v58, v13, 0, s[60:61]
    v_cndmask_b32 v42, 0, v13, s[60:61]
    v_cndmask_b32 v59, v13, 0, s[62:63]
    v_cndmask_b32 v43, 0, v13, s[62:63]
    v_cmp_le_i32 s[56:57], 24, v12
    v_cmp_le_i32 s[58:59], 25, v12
    v_cmp_le_i32 s[60:61], 26, v12
    v_cmp_le_i32 s[62:63], 27, v12
    v_cndmask_b32 v60, v13, 0, s[56:57]
    v_cndmask_b32 v44, 0, v13, s[56:57]
    v_cndmask_b32 v61, v13, 0, s[58:59]
    v_cndmask_b32 v45, 0, v13, s[58:59]
    v_cndmask_b32 v62, v13, 0, s[60:61]
    v_cndmask_b32 v46, 0, v13, s[60:61]
    v_cndmask_b32 v63, v13, 0, s[62:63]
    v_cndmask_b32 v47, 0, v13, s[62:63]
    v_mov_b32 v14, 0xffff
    v_mov_b32 v15, 0xffff0000
    v_cmp_le_i32 s[56:57], 0, v12
    v_cmp_le_i32 s[58:59], 1, v12
    v_cmp_le_i32 s[60:61], 2, v12
    v_cmp_le_i32 s[62:63], 3, v12
    v_cndmask_b32 v221, 0, v14, s[56:57]
    v_cndmask_b32 v13, 0, v15, s[58:59]
    v_or_b32 v221, v221, v13
    v_cndmask_b32 v222, 0, v14, s[60:61]
    v_cndmask_b32 v13, 0, v15, s[62:63]
    v_or_b32 v222, v222, v13
    v_cmp_le_i32 s[56:57], 8, v12
    v_cmp_le_i32 s[58:59], 9, v12
    v_cmp_le_i32 s[60:61], 10, v12
    v_cmp_le_i32 s[62:63], 11, v12
    v_cndmask_b32 v223, 0, v14, s[56:57]
    v_cndmask_b32 v13, 0, v15, s[58:59]
    v_or_b32 v223, v223, v13
    v_cndmask_b32 v224, 0, v14, s[60:61]
    v_cndmask_b32 v13, 0, v15, s[62:63]
    v_or_b32 v224, v224, v13
    v_cmp_le_i32 s[56:57], 16, v12
    v_cmp_le_i32 s[58:59], 17, v12
    v_cmp_le_i32 s[60:61], 18, v12
    v_cmp_le_i32 s[62:63], 19, v12
    v_cndmask_b32 v225, 0, v14, s[56:57]
    v_cndmask_b32 v13, 0, v15, s[58:59]
    v_or_b32 v225, v225, v13
    v_cndmask_b32 v226, 0, v14, s[60:61]
    v_cndmask_b32 v13, 0, v15, s[62:63]
    v_or_b32 v226, v226, v13
    v_cmp_le_i32 s[56:57], 24, v12
    v_cmp_le_i32 s[58:59], 25, v12
    v_cmp_le_i32 s[60:61], 26, v12
    v_cmp_le_i32 s[62:63], 27, v12
    v_cndmask_b32 v227, 0, v14, s[56:57]
    v_cndmask_b32 v13, 0, v15, s[58:59]
    v_or_b32 v227, v227, v13
    v_cndmask_b32 v228, 0, v14, s[60:61]
    v_cndmask_b32 v13, 0, v15, s[62:63]
    v_or_b32 v228, v228, v13
    v_mov_b32 v11, 0xff61b1e6
    v_mov_b32 v13, 0xff61b1e6
    v_mov_b32 v14, 0xff61b1e6
    v_mov_b32 v15, 0xff61b1e6
    v_mul_u32_u24 v160, 48, v0
    s_cmp_eq_u32 s55, 0
    s_cselect_b32 s36, 0xf149, 0
    v_mov_b32 v162, s36
    v_mov_b32 v163, 0
    v_mov_b32 v164, 0x3f80
    v_mov_b32 v165, 0
    s_lshl_b32 s37, s31, 1
    s_sub_u32 s37, s37, 2
    v_and_b32 v236, 3, v2
    v_add_u32 v236, s37, v236
    v_lshrrev_b32 v238, 2, v2
    v_lshlrev_b32 v238, 5, v238
    v_add_u32 v238, s32, v238
    v_mul_u32_u24 v238, 43, v238
    v_lshrrev_b32 v238, 9, v238
    v_and_b32 v237, 7, v236
    v_lshlrev_b32 v237, 5, v237
    v_bfe_u32 v236, v236, 3, 1
    v_lshl_add_u32 v237, v236, 2, v237
    v_and_b32 v236, 1, v238
    v_lshl_add_u32 v237, v236, 3, v237
    v_lshrrev_b32 v238, 1, v238
    v_add_u32 v237, v237, v238
    v_lshlrev_b32 v237, 7, v237
    s_cmp_eq_u32 s31, 0
    s_movk_i32 s36, 0xccc
    s_movk_i32 s37, 0xffc
    s_cselect_b32 s71, s36, s37
    v_and_b32 v31, 31, v2
    v_lshlrev_b32 v31, 4, v31
    v_lshrrev_b32 v236, 5, v2
    v_mul_u32_u24 v236, 384, v236
    v_add_u32 v31, v31, v236
    v_lshlrev_b32 v238, 7, v2
    v_add_u32 v239, 8192, v238
    v_add_u32 v240, 16384, v238
    v_add_u32 v241, 24576, v238
    s_bfe_u32 s29, s2, 0x30003
    s_mul_i32 s29, s29, 204800
    s_add_u32 s24, s29, 19922944
    s_add_u32 s25, s29, 19963904
    s_add_u32 s26, s29, 20004864
    s_add_u32 s27, s29, 20045824
    s_add_u32 s28, s29, 20086784
    s_lshr_b32 s29, s33, 2
    s_lshl_b32 s29, s29, 12
    s_lshl_b32 s30, s33, 12
    s_add_u32 s29, s29, s30
    v_lshlrev_b32 v248, 4, v2
    v_add_u32 v248, s29, v248
    s_mul_i32 s29, s33, 11264
    s_add_u32 s29, s29, 70656
    s_cmp_lg_u32 s33, 0
    s_cbranch_scc1 S1_skip
    s_mov_b32 exec_lo, s71
    s_mov_b32 exec_hi, 0
    s_mov_b32 s95, 200000
POLL1:
        buffer_load_dword v232, v237, s[20:23], s70 offen sc1
        s_waitcnt vmcnt(0)
    v_xor_b32 v232, s94, v232
    v_cmp_ne_u32 vcc, 0, v232
    s_sub_u32 s95, s95, 1
    s_cmp_eq_u32 s95, 0
    s_cbranch_scc1 POLL1_out
    s_nop 2
    s_cbranch_vccz POLL1_out
    s_sleep 1
    s_branch POLL1
POLL1_out:
    s_mov_b32 exec_lo, -1
    s_mov_b32 exec_hi, -1
        s_waitcnt lgkmcnt(0)
S1_skip:
    s_barrier
    s_mov_b32 m0, s40
    s_nop 0
    buffer_load_dwordx4 v249, s[20:23], s42 offen sc1 lds
    s_add_u32 m0, s40, 1024
    s_nop 0
    buffer_load_dwordx4 v250, s[20:23], s42 offen sc1 lds
    s_add_u32 m0, s40, 2048
    s_nop 0
    buffer_load_dwordx4 v251, s[20:23], s42 offen sc1 lds
    buffer_load_dwordx4 v[16:19], v6, s[20:23], s41 offen sc1
    s_mov_b32 exec_hi, 0
    buffer_load_dwordx2 v[20:21], v6, s[20:23], s41 offen offset:32 sc1
    s_mov_b32 exec_hi, -1
    s_add_u32 m0, s40, 24576
    s_nop 0
    buffer_load_dwordx4 v249, s[20:23], s43 offen sc1 lds
    s_add_u32 m0, s40, 25600
    s_nop 0
    buffer_load_dwordx4 v250, s[20:23], s43 offen sc1 lds
    s_add_u32 m0, s40, 26624
    s_nop 0
    buffer_load_dwordx4 v251, s[20:23], s43 offen sc1 lds
    s_waitcnt vmcnt(3)
    ds_write_b64 v160, v[162:163] offset:40
    s_waitcnt lgkmcnt(0)
    s_barrier
    ds_read_b128 v[96:99], v8 offset:0
    ds_read_b128 v[100:103], v9 offset:0
    ds_read_b128 v[104:107], v8 offset:1536
    ds_read_b128 v[108:111], v9 offset:1536
    ds_read_b128 v[112:115], v8 offset:3072
    ds_read_b128 v[116:119], v9 offset:3072
    s_cmp_lg_u32 s33, 0
    s_cbranch_scc1 SM_nopub
    s_cmp_eq_u32 s75, 0
    s_mov_b32 s76, 0x40000000
    v_mov_b32 v232, s94
    v_mov_b32 v233, 0
    s_mov_b32 exec_lo, 1
    s_mov_b32 exec_hi, 0
        buffer_store_dword v232, v233, s[20:23], s76 offen sc1
    s_mov_b32 exec_lo, -1
    s_mov_b32 exec_hi, -1
SM_nopub:
    s_waitcnt lgkmcnt(5)
    v_mfma_f32_32x32x16_bf16 v[64:79], v[96:99], v[16:19], v[32:47]
    s_waitcnt lgkmcnt(4)
    v_mfma_f32_32x32x16_bf16 v[64:79], v[100:103], v[20:23], v[64:79]
    s_waitcnt lgkmcnt(3)
    v_mfma_f32_32x32x16_bf16 v[80:95], v[104:107], v[16:19], 0
    s_waitcnt lgkmcnt(2)
    v_mfma_f32_32x32x16_bf16 v[80:95], v[108:111], v[20:23], v[80:95]
    s_waitcnt lgkmcnt(1)
    v_mfma_f32_32x32x16_bf16 v[144:159], v[112:115], v[16:19], 0
    s_nop 5
    v_max3_f32 v11, v11, v64, v65
    v_max3_f32 v13, v13, v66, v67
    v_max3_f32 v14, v14, v68, v69
    v_max3_f32 v15, v15, v70, v71
    s_waitcnt lgkmcnt(0)
    v_mfma_f32_32x32x16_bf16 v[144:159], v[116:119], v[20:23], v[144:159]
    v_max3_f32 v11, v11, v72, v73
    v_max3_f32 v13, v13, v74, v75
    v_max3_f32 v14, v14, v76, v77
    v_max3_f32 v15, v15, v78, v79
    ds_read_b128 v[96:99], v8 offset:4608
    ds_read_b128 v[100:103], v9 offset:4608
    s_waitcnt lgkmcnt(1)
    v_mfma_f32_32x32x16_bf16 v[64:79], v[96:99], v[16:19], 0
    v_max3_f32 v11, v11, v80, v81
    v_max3_f32 v13, v13, v82, v83
    v_max3_f32 v14, v14, v84, v85
    v_max3_f32 v15, v15, v86, v87
    s_waitcnt lgkmcnt(0)
    v_mfma_f32_32x32x16_bf16 v[64:79], v[100:103], v[20:23], v[64:79]
    v_max3_f32 v11, v11, v88, v89
    v_max3_f32 v13, v13, v90, v91
    v_max3_f32 v14, v14, v92, v93
    v_max3_f32 v15, v15, v94, v95
    ds_read_b128 v[104:107], v8 offset:6144
    ds_read_b128 v[108:111], v9 offset:6144
    s_waitcnt lgkmcnt(1)
    v_mfma_f32_32x32x16_bf16 v[80:95], v[104:107], v[16:19], 0
    v_max3_f32 v11, v11, v144, v145
    v_max3_f32 v13, v13, v146, v147
    v_max3_f32 v14, v14, v148, v149
    v_max3_f32 v15, v15, v150, v151
    s_waitcnt lgkmcnt(0)
    v_mfma_f32_32x32x16_bf16 v[80:95], v[108:111], v[20:23], v[80:95]
    v_max3_f32 v11, v11, v152, v153
    v_max3_f32 v13, v13, v154, v155
    v_max3_f32 v14, v14, v156, v157
    v_max3_f32 v15, v15, v158, v159
    ds_read_b128 v[112:115], v8 offset:7680
    ds_read_b128 v[116:119], v9 offset:7680
    s_waitcnt lgkmcnt(1)
    v_mfma_f32_32x32x16_bf16 v[144:159], v[112:115], v[16:19], 0
    v_max3_f32 v11, v11, v64, v65
    v_max3_f32 v13, v13, v66, v67
    v_max3_f32 v14, v14, v68, v69
    v_max3_f32 v15, v15, v70, v71
    s_waitcnt lgkmcnt(0)
    v_mfma_f32_32x32x16_bf16 v[144:159], v[116:119], v[20:23], v[144:159]
    v_max3_f32 v11, v11, v72, v73
    v_max3_f32 v13, v13, v74, v75
    v_max3_f32 v14, v14, v76, v77
    v_max3_f32 v15, v15, v78, v79
    ds_read_b128 v[96:99], v8 offset:9216
    ds_read_b128 v[100:103], v9 offset:9216
    s_cmp_eq_u32 s33, 0
    s_cbranch_scc1 P2_vw
    s_waitcnt vmcnt(0)
P2_vw:
        s_waitcnt vmcnt(1)
    ds_write_b64 v160, v[164:165] offset:24616
    s_waitcnt lgkmcnt(0)
    s_barrier
    s_cmp_lg_u32 s33, 0
    s_cbranch_scc1 SM_skip
        buffer_load_dword v242, v238, s[20:23], s70 offen sc1
        buffer_load_dword v243, v239, s[20:23], s70 offen sc1
        buffer_load_dword v244, v240, s[20:23], s70 offen sc1
        buffer_load_dword v245, v241, s[20:23], s70 offen sc1
SM_skip:
    v_mfma_f32_32x32x16_bf16 v[64:79], v[96:99], v[16:19], 0
    v_max3_f32 v11, v11, v80, v81
    v_max3_f32 v13, v13, v82, v83
    v_max3_f32 v14, v14, v84, v85
    v_max3_f32 v15, v15, v86, v87
    v_mfma_f32_32x32x16_bf16 v[64:79], v[100:103], v[20:23], v[64:79]
    v_max3_f32 v11, v11, v88, v89
    v_max3_f32 v13, v13, v90, v91
    v_max3_f32 v14, v14, v92, v93
    v_max3_f32 v15, v15, v94, v95
    ds_read_b128 v[104:107], v8 offset:10752
    ds_read_b128 v[108:111], v9 offset:10752
    s_waitcnt lgkmcnt(1)
    v_mfma_f32_32x32x16_bf16 v[80:95], v[104:107], v[16:19], 0
    v_max3_f32 v11, v11, v144, v145
    v_max3_f32 v13, v13, v146, v147
    v_max3_f32 v14, v14, v148, v149
    v_max3_f32 v15, v15, v150, v151
    s_waitcnt lgkmcnt(0)
    v_mfma_f32_32x32x16_bf16 v[80:95], v[108:111], v[20:23], v[80:95]
    v_max3_f32 v11, v11, v152, v153
    v_max3_f32 v13, v13, v154, v155
    v_max3_f32 v14, v14, v156, v157
    v_max3_f32 v15, v15, v158, v159
    ds_read_b128 v[112:115], v8 offset:12288
    ds_read_b128 v[116:119], v9 offset:12288
    s_waitcnt lgkmcnt(1)
    v_mfma_f32_32x32x16_bf16 v[144:159], v[112:115], v[16:19], v[48:63]
    v_max3_f32 v11, v11, v64, v65
    v_max3_f32 v13, v13, v66, v67
    v_max3_f32 v14, v14, v68, v69
    v_max3_f32 v15, v15, v70, v71
    s_waitcnt lgkmcnt(0)
    v_mfma_f32_32x32x16_bf16 v[144:159], v[116:119], v[20:23], v[144:159]
    v_max3_f32 v11, v11, v72, v73
    v_max3_f32 v13, v13, v74, v75
    v_max3_f32 v14, v14, v76, v77
    v_max3_f32 v15, v15, v78, v79
    v_max3_f32 v11, v11, v80, v81
    v_max3_f32 v13, v13, v82, v83
    v_max3_f32 v14, v14, v84, v85
    v_max3_f32 v15, v15, v86, v87
    v_max3_f32 v11, v11, v88, v89
    v_max3_f32 v13, v13, v90, v91
    v_max3_f32 v14, v14, v92, v93
    v_max3_f32 v15, v15, v94, v95
    v_max3_f32 v11, v11, v144, v145
    v_max3_f32 v13, v13, v146, v147
    v_max3_f32 v14, v14, v148, v149
    v_max3_f32 v15, v15, v150, v151
    v_max3_f32 v11, v11, v152, v153
    v_max3_f32 v13, v13, v154, v155
    v_max3_f32 v14, v14, v156, v157
    v_max3_f32 v15, v15, v158, v159
    ds_read_b128 v[96:99], v8 offset:0
    ds_read_b128 v[100:103], v9 offset:0
    ds_read_b128 v[104:107], v8 offset:12288
    ds_read_b128 v[108:111], v9 offset:12288
    v_max3_f32 v11, v11, v13, v14
    v_max_f32 v11, v11, v15
    v_mov_b32 v12, v11
    s_nop 1
    v_permlane32_swap_b32 v11, v12
    v_max_f32 v11, v11, v12
    v_sub_f32 v160, 0, v11
    v_sub_f32 v161, 0, v11
    v_pk_add_f32 v[32:33], v[32:33], v[160:161]
    v_pk_add_f32 v[34:35], v[34:35], v[160:161]
    v_pk_add_f32 v[36:37], v[36:37], v[160:161]
    v_pk_add_f32 v[38:39], v[38:39], v[160:161]
    v_pk_add_f32 v[40:41], v[40:41], v[160:161]
    v_pk_add_f32 v[42:43], v[42:43], v[160:161]
    v_pk_add_f32 v[44:45], v[44:45], v[160:161]
    v_pk_add_f32 v[46:47], v[46:47], v[160:161]
    v_mov_b32 v162, v160
    v_mov_b32 v163, v160
    v_mov_b32 v164, v160
    v_mov_b32 v165, v160
    v_mov_b32 v166, v160
    v_mov_b32 v167, v160
    v_mov_b32 v168, v160
    v_mov_b32 v169, v160
    v_mov_b32 v170, v160
    v_mov_b32 v171, v160
    v_mov_b32 v172, v160
    v_mov_b32 v173, v160
    v_mov_b32 v174, v160
    v_mov_b32 v175, v160
    v_pk_add_f32 v[48:49], v[48:49], v[160:161]
    v_pk_add_f32 v[50:51], v[50:51], v[160:161]
    v_pk_add_f32 v[52:53], v[52:53], v[160:161]
    v_pk_add_f32 v[54:55], v[54:55], v[160:161]
    v_pk_add_f32 v[56:57], v[56:57], v[160:161]
    v_pk_add_f32 v[58:59], v[58:59], v[160:161]
    v_pk_add_f32 v[60:61], v[60:61], v[160:161]
    v_pk_add_f32 v[62:63], v[62:63], v[160:161]
    s_cmp_lg_u32 s33, 0
    s_cbranch_scc1 SA_done
        s_waitcnt vmcnt(0)
    v_xor_b32 v242, s94, v242
    v_xor_b32 v243, s94, v243
    v_xor_b32 v244, s94, v244
    v_xor_b32 v245, s94, v245
    v_or3_b32 v242, v242, v243, v244
    v_or_b32 v242, v242, v245
    v_cmp_ne_u32 vcc, 0, v242
    s_nop 4
    s_cbranch_vccz SA_skip
    s_mov_b32 s95, 200000
POLL2:
        buffer_load_dword v232, v238, s[20:23], s70 offen sc1
        buffer_load_dword v233, v239, s[20:23], s70 offen sc1
        buffer_load_dword v234, v240, s[20:23], s70 offen sc1
        buffer_load_dword v235, v241, s[20:23], s70 offen sc1
        s_waitcnt vmcnt(0)
    v_xor_b32 v232, s94, v232
    v_xor_b32 v233, s94, v233
    v_or_b32 v232, v232, v233
    v_xor_b32 v234, s94, v234
    v_or_b32 v232, v232, v234
    v_xor_b32 v235, s94, v235
    v_or_b32 v232, v232, v235
    v_cmp_ne_u32 vcc, 0, v232
    s_sub_u32 s95, s95, 1
    s_cmp_eq_u32 s95, 0
    s_cbranch_scc1 POLL2_out
    s_nop 2
    s_cbranch_vccz POLL2_out
    s_sleep 1
    s_branch POLL2
POLL2_out:
    s_mov_b32 exec_lo, -1
    s_mov_b32 exec_hi, -1
SA_skip:
    v_mov_b32 v232, 161792
    v_mov_b32 v233, 1
        ds_write_b32 v232, v233
        s_waitcnt lgkmcnt(0)
SA_done:
    s_waitcnt lgkmcnt(3)
    v_mfma_f32_32x32x16_bf16 v[64:79], v[96:99], v[16:19], v[32:47]
    s_waitcnt lgkmcnt(2)
    v_mfma_f32_32x32x16_bf16 v[64:79], v[100:103], v[20:23], v[64:79]
    s_waitcnt lgkmcnt(1)
    v_mfma_f32_32x32x16_bf16 v[80:95], v[104:107], v[16:19], v[48:63]
    s_waitcnt lgkmcnt(0)
    v_mfma_f32_32x32x16_bf16 v[80:95], v[108:111], v[20:23], v[80:95]
    ds_read_b128 v[96:99], v8 offset:1536
    ds_read_b128 v[100:103], v9 offset:1536
    ds_read_b128 v[104:107], v8 offset:3072
    ds_read_b128 v[108:111], v9 offset:3072
    ds_read_b64_tr_b16 v[112:113], v10 offset:0
    ds_read_b64_tr_b16 v[114:115], v10 offset:384
    ds_read_b64_tr_b16 v[116:117], v10 offset:768
    ds_read_b64_tr_b16 v[118:119], v10 offset:1152
    ds_read_b64_tr_b16 v[120:121], v10 offset:12288
    ds_read_b64_tr_b16 v[122:123], v10 offset:12672
    ds_read_b64_tr_b16 v[124:125], v10 offset:13056
    ds_read_b64_tr_b16 v[126:127], v10 offset:13440
    v_max_f32 v64, v64, v80
    v_max_f32 v65, v65, v81
    v_max_f32 v66, v66, v82
    v_max_f32 v67, v67, v83
    v_max_f32 v68, v68, v84
    v_max_f32 v69, v69, v85
    v_max_f32 v70, v70, v86
    v_max_f32 v71, v71, v87
    v_max_f32 v72, v72, v88
    v_max_f32 v73, v73, v89
    v_max_f32 v74, v74, v90
    v_max_f32 v75, v75, v91
    v_max_f32 v76, v76, v92
    v_max_f32 v77, v77, v93
    v_max_f32 v78, v78, v94
    v_max_f32 v79, v79, v95
    v_exp_f32 v64, v64
    s_waitcnt lgkmcnt(11)
    v_mfma_f32_32x32x16_bf16 v[80:95], v[96:99], v[16:19], v[160:175]
    v_exp_f32 v65, v65
    v_exp_f32 v66, v66
    v_exp_f32 v67, v67
    v_exp_f32 v68, v68
    s_waitcnt lgkmcnt(10)
    v_mfma_f32_32x32x16_bf16 v[80:95], v[100:103], v[20:23], v[80:95]
    v_exp_f32 v69, v69
    ds_read_b128 v[96:99], v8 offset:4608
    ds_read_b128 v[100:103], v9 offset:4608
    v_exp_f32 v70, v70
    v_exp_f32 v71, v71
    v_exp_f32 v72, v72
    v_exp_f32 v73, v73
    v_exp_f32 v74, v74
    v_exp_f32 v75, v75
    v_exp_f32 v76, v76
    v_exp_f32 v77, v77
    v_exp_f32 v78, v78
    v_exp_f32 v79, v79
    v_cvt_pk_bf16_f32 v128, v64, v65
    v_cvt_pk_bf16_f32 v129, v66, v67
    v_cvt_pk_bf16_f32 v130, v68, v69
    v_cvt_pk_bf16_f32 v131, v70, v71
    v_cvt_pk_bf16_f32 v132, v72, v73
    v_cvt_pk_bf16_f32 v133, v74, v75
    v_cvt_pk_bf16_f32 v134, v76, v77
    v_cvt_pk_bf16_f32 v135, v78, v79
    v_and_b32 v136, v128, v221
    v_and_b32 v137, v129, v222
    v_and_b32 v138, v130, v223
    v_and_b32 v139, v131, v224
    v_and_b32 v140, v132, v225
    v_and_b32 v141, v133, v226
    v_and_b32 v142, v134, v227
    v_and_b32 v143, v135, v228
    v_xor_b32 v128, v128, v136
    v_xor_b32 v129, v129, v137
    v_xor_b32 v130, v130, v138
    v_xor_b32 v131, v131, v139
    v_xor_b32 v132, v132, v140
    v_xor_b32 v133, v133, v141
    v_xor_b32 v134, v134, v142
    v_xor_b32 v135, v135, v143
    v_mov_b32 v232, 161792
    s_mov_b32 s95, 1600000
    s_waitcnt lgkmcnt(0)
WB_loop:
        ds_read_b32 v233, v232
        s_waitcnt lgkmcnt(0)
    v_readfirstlane_b32 s73, v233
    s_sub_u32 s95, s95, 1
    s_cmp_eq_u32 s95, 0
    s_cbranch_scc1 WB_out
    s_cmp_eq_u32 s73, 0
    s_cbranch_scc0 WB_out
    s_sleep 1
    s_branch WB_loop
WB_out:
    v_exp_f32 v80, v80
    v_mfma_f32_32x32x16_bf16 v[64:79], v[104:107], v[16:19], v[160:175]
    v_exp_f32 v81, v81
    v_exp_f32 v82, v82
    s_mul_i32 s45, s33, 1280
    s_add_u32 m0, s45, 57664
    s_add_u32 s45, s45, s44
    buffer_load_dwordx4 v3, s[20:23], s45 offen sc1 lds
    v_exp_f32 v83, v83
    v_mfma_f32_32x32x16_bf16 v[64:79], v[108:111], v[20:23], v[64:79]
    v_exp_f32 v84, v84
    ds_read_b128 v[104:107], v8 offset:6144
    ds_read_b128 v[108:111], v9 offset:6144
    v_exp_f32 v85, v85
    s_mov_b32 exec_lo, 0xffff
    s_mov_b32 exec_hi, 0
    buffer_load_dwordx4 v3, s[20:23], s45 offen offset:1024 sc1 lds
    s_mov_b32 exec_lo, -1
    s_mov_b32 exec_hi, -1
    v_exp_f32 v86, v86
    v_mfma_f32_32x32x16_bf16 v[144:159], v[112:115], v[128:131], 0
    v_exp_f32 v87, v87
    buffer_load_dwordx4 v[176:179], v3, s[20:23], s66 offen offset:0 sc1
    v_exp_f32 v88, v88
    v_exp_f32 v89, v89
    v_mfma_f32_32x32x16_bf16 v[144:159], v[116:119], v[132:135], v[144:159]
    v_exp_f32 v90, v90
    ds_read_b64_tr_b16 v[112:113], v10 offset:1536
    ds_read_b64_tr_b16 v[114:115], v10 offset:1920
    ds_read_b64_tr_b16 v[116:117], v10 offset:2304
    ds_read_b64_tr_b16 v[118:119], v10 offset:2688
    v_exp_f32 v91, v91
    buffer_load_dwordx4 v[180:183], v3, s[20:23], s66 offen offset:2304 sc1
    s_add_u32 s66, s66, 4608
    v_exp_f32 v92, v92
    v_mfma_f32_32x32x16_bf16 v[144:159], v[120:123], v[136:139], v[144:159]
    v_exp_f32 v93, v93
    buffer_load_dwordx4 v[184:187], v3, s[20:23], s66 offen offset:0 sc1
    v_exp_f32 v94, v94
    buffer_load_dwordx4 v[188:191], v3, s[20:23], s66 offen offset:2304 sc1
    s_add_u32 s66, s66, 4608
    v_exp_f32 v95, v95
    v_mfma_f32_32x32x16_bf16 v[144:159], v[124:127], v[140:143], v[144:159]
    v_cvt_pk_bf16_f32 v128, v80, v81
    v_cvt_pk_bf16_f32 v129, v82, v83
    v_cvt_pk_bf16_f32 v130, v84, v85
    v_cvt_pk_bf16_f32 v131, v86, v87
    v_cvt_pk_bf16_f32 v132, v88, v89
    v_cvt_pk_bf16_f32 v133, v90, v91
    v_cvt_pk_bf16_f32 v134, v92, v93
    v_cvt_pk_bf16_f32 v135, v94, v95
    v_exp_f32 v64, v64
    v_mfma_f32_32x32x16_bf16 v[80:95], v[96:99], v[16:19], v[160:175]
    v_exp_f32 v65, v65
    ds_read_b64_tr_b16 v[120:121], v10 offset:3072
    ds_read_b64_tr_b16 v[122:123], v10 offset:3456
    ds_read_b64_tr_b16 v[124:125], v10 offset:3840
    ds_read_b64_tr_b16 v[126:127], v10 offset:4224
    v_exp_f32 v66, v66
    buffer_load_dwordx4 v[192:195], v3, s[20:23], s66 offen offset:0 sc1
    v_exp_f32 v67, v67
    v_mfma_f32_32x32x16_bf16 v[80:95], v[100:103], v[20:23], v[80:95]
    v_exp_f32 v68, v68
    ds_read_b128 v[96:99], v8 offset:7680
    ds_read_b128 v[100:103], v9 offset:7680
    v_exp_f32 v69, v69
    buffer_load_dwordx4 v[196:199], v3, s[20:23], s66 offen offset:2304 sc1
    s_add_u32 s66, s66, 4608
    v_exp_f32 v70, v70
    v_exp_f32 v71, v71
    buffer_load_dwordx4 v[200:203], v3, s[20:23], s66 offen offset:0 sc1
    v_exp_f32 v72, v72
    s_waitcnt lgkmcnt(8)
    v_mfma_f32_32x32x16_bf16 v[144:159], v[112:115], v[128:131], v[144:159]
    v_exp_f32 v73, v73
    v_exp_f32 v74, v74
    v_exp_f32 v75, v75
    buffer_load_dwordx4 v[204:207], v3, s[20:23], s66 offen offset:2304 sc1
    s_add_u32 s66, s66, 4608
    v_exp_f32 v76, v76
    s_waitcnt lgkmcnt(6)
    v_mfma_f32_32x32x16_bf16 v[144:159], v[116:119], v[132:135], v[144:159]
    v_exp_f32 v77, v77
    s_add_u32 m0, s29, 0
    s_nop 0
    buffer_load_dwordx4 v248, s[20:23], s24 offen offset:0 sc1 lds
    v_exp_f32 v78, v78
    s_add_u32 m0, s29, 1024
    s_nop 0
    buffer_load_dwordx4 v248, s[20:23], s25 offen offset:0 sc1 lds
    v_exp_f32 v79, v79
    v_cvt_pk_bf16_f32 v136, v64, v65
    v_cvt_pk_bf16_f32 v137, v66, v67
    v_cvt_pk_bf16_f32 v138, v68, v69
    v_cvt_pk_bf16_f32 v139, v70, v71
    v_cvt_pk_bf16_f32 v140, v72, v73
    v_cvt_pk_bf16_f32 v141, v74, v75
    v_cvt_pk_bf16_f32 v142, v76, v77
    v_cvt_pk_bf16_f32 v143, v78, v79
    v_exp_f32 v80, v80
    v_mfma_f32_32x32x16_bf16 v[64:79], v[104:107], v[16:19], v[160:175]
    v_exp_f32 v81, v81
    ds_read_b64_tr_b16 v[112:113], v10 offset:4608
    ds_read_b64_tr_b16 v[114:115], v10 offset:4992
    ds_read_b64_tr_b16 v[116:117], v10 offset:5376
    ds_read_b64_tr_b16 v[118:119], v10 offset:5760
    v_exp_f32 v82, v82
    s_add_u32 m0, s29, 2048
    s_nop 0
    buffer_load_dwordx4 v248, s[20:23], s26 offen offset:0 sc1 lds
    v_exp_f32 v83, v83
    v_mfma_f32_32x32x16_bf16 v[64:79], v[108:111], v[20:23], v[64:79]
    v_exp_f32 v84, v84
    ds_read_b128 v[104:107], v8 offset:9216
    ds_read_b128 v[108:111], v9 offset:9216
    v_exp_f32 v85, v85
    s_add_u32 m0, s29, 3072
    s_nop 0
    buffer_load_dwordx4 v248, s[20:23], s27 offen offset:0 sc1 lds
    v_exp_f32 v86, v86
    v_exp_f32 v87, v87
    s_add_u32 m0, s29, 4096
    s_nop 0
    buffer_load_dwordx4 v248, s[20:23], s28 offen offset:0 sc1 lds
    v_exp_f32 v88, v88
    s_waitcnt lgkmcnt(10)
    v_mfma_f32_32x32x16_bf16 v[144:159], v[120:123], v[136:139], v[144:159]
    v_exp_f32 v89, v89
    v_exp_f32 v90, v90
    v_exp_f32 v91, v91
    s_add_u32 m0, s29, 4096
    s_nop 0
    buffer_load_dwordx4 v248, s[20:23], s24 offen offset:1024 sc1 lds
    v_exp_f32 v92, v92
    s_waitcnt lgkmcnt(8)
    v_mfma_f32_32x32x16_bf16 v[144:159], v[124:127], v[140:143], v[144:159]
    v_exp_f32 v93, v93
    s_add_u32 m0, s29, 5120
    s_nop 0
    buffer_load_dwordx4 v248, s[20:23], s25 offen offset:1024 sc1 lds
    v_exp_f32 v94, v94
    s_add_u32 m0, s29, 6144
    s_nop 0
    buffer_load_dwordx4 v248, s[20:23], s26 offen offset:1024 sc1 lds
    v_exp_f32 v95, v95
    v_cvt_pk_bf16_f32 v128, v80, v81
    v_cvt_pk_bf16_f32 v129, v82, v83
    v_cvt_pk_bf16_f32 v130, v84, v85
    v_cvt_pk_bf16_f32 v131, v86, v87
    v_cvt_pk_bf16_f32 v132, v88, v89
    v_cvt_pk_bf16_f32 v133, v90, v91
    v_cvt_pk_bf16_f32 v134, v92, v93
    v_cvt_pk_bf16_f32 v135, v94, v95
    v_exp_f32 v64, v64
    s_waitcnt lgkmcnt(7)
    v_mfma_f32_32x32x16_bf16 v[80:95], v[96:99], v[16:19], v[160:175]
    v_exp_f32 v65, v65
    ds_read_b64_tr_b16 v[120:121], v10 offset:6144
    ds_read_b64_tr_b16 v[122:123], v10 offset:6528
    ds_read_b64_tr_b16 v[124:125], v10 offset:6912
    ds_read_b64_tr_b16 v[126:127], v10 offset:7296
    v_exp_f32 v66, v66
    s_add_u32 m0, s29, 7168
    s_nop 0
    buffer_load_dwordx4 v248, s[20:23], s27 offen offset:1024 sc1 lds
    v_exp_f32 v67, v67
    s_waitcnt lgkmcnt(10)
    v_mfma_f32_32x32x16_bf16 v[80:95], v[100:103], v[20:23], v[80:95]
    v_exp_f32 v68, v68
    ds_read_b128 v[96:99], v8 offset:10752
    ds_read_b128 v[100:103], v9 offset:10752
    v_exp_f32 v69, v69
    s_add_u32 m0, s29, 8192
    s_nop 0
    buffer_load_dwordx4 v248, s[20:23], s28 offen offset:1024 sc1 lds
    v_exp_f32 v70, v70
    v_exp_f32 v71, v71
    s_add_u32 m0, s29, 8192
    s_nop 0
    buffer_load_dwordx4 v248, s[20:23], s24 offen offset:2048 sc1 lds
    v_exp_f32 v72, v72
    s_waitcnt lgkmcnt(10)
    v_mfma_f32_32x32x16_bf16 v[144:159], v[112:115], v[128:131], v[144:159]
    v_exp_f32 v73, v73
    v_exp_f32 v74, v74
    v_exp_f32 v75, v75
    v_exp_f32 v76, v76
    s_waitcnt lgkmcnt(8)
    v_mfma_f32_32x32x16_bf16 v[144:159], v[116:119], v[132:135], v[144:159]
    v_exp_f32 v77, v77
    v_exp_f32 v78, v78
    v_exp_f32 v79, v79
    v_cvt_pk_bf16_f32 v136, v64, v65
    v_cvt_pk_bf16_f32 v137, v66, v67
    v_cvt_pk_bf16_f32 v138, v68, v69
    v_cvt_pk_bf16_f32 v139, v70, v71
    v_cvt_pk_bf16_f32 v140, v72, v73
    v_cvt_pk_bf16_f32 v141, v74, v75
    v_cvt_pk_bf16_f32 v142, v76, v77
    v_cvt_pk_bf16_f32 v143, v78, v79
    v_exp_f32 v80, v80
    s_waitcnt lgkmcnt(7)
    v_mfma_f32_32x32x16_bf16 v[64:79], v[104:107], v[16:19], v[160:175]
    v_exp_f32 v81, v81
    ds_read_b64_tr_b16 v[112:113], v10 offset:7680
    ds_read_b64_tr_b16 v[114:115], v10 offset:8064
    ds_read_b64_tr_b16 v[116:117], v10 offset:8448
    ds_read_b64_tr_b16 v[118:119], v10 offset:8832
    v_exp_f32 v82, v82
    v_exp_f32 v83, v83
    s_waitcnt lgkmcnt(10)
    v_mfma_f32_32x32x16_bf16 v[64:79], v[108:111], v[20:23], v[64:79]
    v_exp_f32 v84, v84
    v_exp_f32 v85, v85
    v_exp_f32 v86, v86
    v_exp_f32 v87, v87
    v_exp_f32 v88, v88
    s_waitcnt lgkmcnt(8)
    v_mfma_f32_32x32x16_bf16 v[144:159], v[120:123], v[136:139], v[144:159]
    v_exp_f32 v89, v89
    v_exp_f32 v90, v90
    v_exp_f32 v91, v91
    v_exp_f32 v92, v92
    s_waitcnt lgkmcnt(6)
    v_mfma_f32_32x32x16_bf16 v[144:159], v[124:127], v[140:143], v[144:159]
    v_exp_f32 v93, v93
    v_exp_f32 v94, v94
    v_exp_f32 v95, v95
    v_cvt_pk_bf16_f32 v128, v80, v81
    v_cvt_pk_bf16_f32 v129, v82, v83
    v_cvt_pk_bf16_f32 v130, v84, v85
    v_cvt_pk_bf16_f32 v131, v86, v87
    v_cvt_pk_bf16_f32 v132, v88, v89
    v_cvt_pk_bf16_f32 v133, v90, v91
    v_cvt_pk_bf16_f32 v134, v92, v93
    v_cvt_pk_bf16_f32 v135, v94, v95
    s_waitcnt vmcnt(17)
    v_pk_add_f32 v[176:177], v[176:177], v[180:181]
    v_pk_add_f32 v[178:179], v[178:179], v[182:183]
    s_waitcnt vmcnt(15)
    v_pk_add_f32 v[184:185], v[184:185], v[188:189]
    v_pk_add_f32 v[186:187], v[186:187], v[190:191]
    s_waitcnt vmcnt(13)
    v_pk_add_f32 v[192:193], v[192:193], v[196:197]
    v_pk_add_f32 v[194:195], v[194:195], v[198:199]
    s_waitcnt vmcnt(11)
    v_pk_add_f32 v[200:201], v[200:201], v[204:205]
    v_pk_add_f32 v[202:203], v[202:203], v[206:207]
    v_pk_add_f32 v[176:177], v[176:177], v[184:185]
    v_pk_add_f32 v[178:179], v[178:179], v[186:187]
    v_pk_add_f32 v[192:193], v[192:193], v[200:201]
    v_pk_add_f32 v[194:195], v[194:195], v[202:203]
    v_pk_add_f32 v[176:177], v[176:177], v[192:193]
    v_pk_add_f32 v[178:179], v[178:179], v[194:195]
    s_lshl_b32 s36, s33, 10
    s_add_u32 s36, s36, 49216
    v_add_u32 v12, s36, v3
    ds_write_b128 v12, v[176:179]
    v_exp_f32 v64, v64
    s_waitcnt lgkmcnt(6)
    v_mfma_f32_32x32x16_bf16 v[80:95], v[96:99], v[16:19], v[160:175]
    v_exp_f32 v65, v65
    ds_read_b64_tr_b16 v[120:121], v10 offset:9216
    ds_read_b64_tr_b16 v[122:123], v10 offset:9600
    ds_read_b64_tr_b16 v[124:125], v10 offset:9984
    ds_read_b64_tr_b16 v[126:127], v10 offset:10368
    v_exp_f32 v66, v66
    v_exp_f32 v67, v67
    s_waitcnt lgkmcnt(9)
    v_mfma_f32_32x32x16_bf16 v[80:95], v[100:103], v[20:23], v[80:95]
    v_exp_f32 v68, v68
    v_exp_f32 v69, v69
    v_exp_f32 v70, v70
    v_exp_f32 v71, v71
    v_exp_f32 v72, v72
    s_waitcnt lgkmcnt(7)
    v_mfma_f32_32x32x16_bf16 v[144:159], v[112:115], v[128:131], v[144:159]
    v_exp_f32 v73, v73
    v_exp_f32 v74, v74
    v_exp_f32 v75, v75
    v_exp_f32 v76, v76
    s_waitcnt lgkmcnt(5)
    v_mfma_f32_32x32x16_bf16 v[144:159], v[116:119], v[132:135], v[144:159]
    v_exp_f32 v77, v77
    v_exp_f32 v78, v78
    v_exp_f32 v79, v79
    v_cvt_pk_bf16_f32 v136, v64, v65
    v_cvt_pk_bf16_f32 v137, v66, v67
    v_cvt_pk_bf16_f32 v138, v68, v69
    v_cvt_pk_bf16_f32 v139, v70, v71
    v_cvt_pk_bf16_f32 v140, v72, v73
    v_cvt_pk_bf16_f32 v141, v74, v75
    v_cvt_pk_bf16_f32 v142, v76, v77
    v_cvt_pk_bf16_f32 v143, v78, v79
    s_waitcnt lgkmcnt(0)
    s_barrier
    s_waitcnt vmcnt(19)
    v_add_u32 v12, 57664, v7
    ds_read_b64 v[24:25], v12 offset:0
    ds_read_b64 v[26:27], v12 offset:16
    ds_read_b64 v[28:29], v12 offset:32
    v_exp_f32 v80, v80
    v_exp_f32 v81, v81
    ds_read_b64_tr_b16 v[112:113], v10 offset:10752
    ds_read_b64_tr_b16 v[114:115], v10 offset:11136
    ds_read_b64_tr_b16 v[116:117], v10 offset:11520
    ds_read_b64_tr_b16 v[118:119], v10 offset:11904
    v_exp_f32 v82, v82
    v_exp_f32 v83, v83
    v_exp_f32 v84, v84
    v_exp_f32 v85, v85
    v_exp_f32 v86, v86
    v_exp_f32 v87, v87
    v_exp_f32 v88, v88
    v_mfma_f32_32x32x16_bf16 v[144:159], v[120:123], v[136:139], v[144:159]
    v_exp_f32 v89, v89
    v_exp_f32 v90, v90
    v_exp_f32 v91, v91
    v_exp_f32 v92, v92
    v_mfma_f32_32x32x16_bf16 v[144:159], v[124:127], v[140:143], v[144:159]
    v_exp_f32 v93, v93
    v_exp_f32 v94, v94
    v_exp_f32 v95, v95
    v_cvt_pk_bf16_f32 v128, v80, v81
    v_cvt_pk_bf16_f32 v129, v82, v83
    v_cvt_pk_bf16_f32 v130, v84, v85
    v_cvt_pk_bf16_f32 v131, v86, v87
    v_cvt_pk_bf16_f32 v132, v88, v89
    v_cvt_pk_bf16_f32 v133, v90, v91
    v_cvt_pk_bf16_f32 v134, v92, v93
    v_cvt_pk_bf16_f32 v135, v94, v95
    s_mov_b32 s53, 0x3fb8aa3b
    s_mov_b32 s54, 0x358637bd
    s_waitcnt lgkmcnt(6)
    v_lshlrev_b32 v176, 16, v24
    v_and_b32 v177, 0xffff0000, v24
    v_lshlrev_b32 v178, 16, v25
    v_and_b32 v179, 0xffff0000, v25
    s_waitcnt lgkmcnt(5)
    v_lshlrev_b32 v180, 16, v26
    v_and_b32 v181, 0xffff0000, v26
    v_lshlrev_b32 v182, 16, v27
    v_and_b32 v183, 0xffff0000, v27
    s_waitcnt lgkmcnt(4)
    v_lshlrev_b32 v184, 16, v28
    v_and_b32 v185, 0xffff0000, v28
    v_lshlrev_b32 v186, 16, v29
    v_and_b32 v187, 0xffff0000, v29
    v_mul_f32 v188, s53, v176
    v_mul_f32 v189, s53, v177
    v_mul_f32 v190, s53, v178
    v_mul_f32 v191, s53, v179
    v_mul_f32 v192, s53, v180
    v_mul_f32 v193, s53, v181
    v_mul_f32 v194, s53, v182
    v_mul_f32 v195, s53, v183
    v_mul_f32 v196, s53, v184
    v_mul_f32 v197, s53, v185
    v_mul_f32 v198, s53, v186
    v_mul_f32 v199, s53, v187
    v_exp_f32 v188, v188 clamp
    v_exp_f32 v189, v189 clamp
    v_exp_f32 v190, v190 clamp
    v_exp_f32 v191, v191 clamp
    v_exp_f32 v192, v192 clamp
    v_exp_f32 v193, v193 clamp
    v_exp_f32 v194, v194 clamp
    v_exp_f32 v195, v195 clamp
    v_exp_f32 v196, v196 clamp
    v_exp_f32 v197, v197 clamp
    v_exp_f32 v198, v198 clamp
    v_exp_f32 v199, v199 clamp
    v_max_f32 v176, 0, v176
    v_max_f32 v177, 0, v177
    v_max_f32 v178, 0, v178
    v_max_f32 v179, 0, v179
    v_max_f32 v180, 0, v180
    v_max_f32 v181, 0, v181
    v_max_f32 v182, 0, v182
    v_max_f32 v183, 0, v183
    v_max_f32 v184, 0, v184
    v_max_f32 v185, 0, v185
    v_max_f32 v186, 0, v186
    v_max_f32 v187, 0, v187
    v_add_f32 v176, v176, v188
    v_add_f32 v177, v177, v189
    v_add_f32 v178, v178, v190
    v_add_f32 v179, v179, v191
    v_add_f32 v180, v180, v192
    v_add_f32 v181, v181, v193
    v_add_f32 v182, v182, v194
    v_add_f32 v183, v183, v195
    v_add_f32 v184, v184, v196
    v_add_f32 v185, v185, v197
    v_add_f32 v186, v186, v198
    v_add_f32 v187, v187, v199
    v_add_f32 v176, s54, v176
    v_add_f32 v177, s54, v177
    v_add_f32 v178, s54, v178
    v_add_f32 v179, s54, v179
    v_add_f32 v180, s54, v180
    v_add_f32 v181, s54, v181
    v_add_f32 v182, s54, v182
    v_add_f32 v183, s54, v183
    v_add_f32 v184, s54, v184
    v_add_f32 v185, s54, v185
    v_add_f32 v186, s54, v186
    v_add_f32 v187, s54, v187
    v_cvt_pk_bf16_f32 v208, v176, v177
    v_cvt_pk_bf16_f32 v209, v178, v179
    v_cvt_pk_bf16_f32 v210, v180, v181
    v_cvt_pk_bf16_f32 v211, v182, v183
    v_cvt_pk_bf16_f32 v212, v184, v185
    v_cvt_pk_bf16_f32 v213, v186, v187
    v_mov_b32 v214, 0
    v_mov_b32 v215, 0
    s_mov_b32 exec_lo, 0
    v_mov_b32 v212, 0
    v_mov_b32 v213, 0
    s_mov_b32 exec_lo, -1
    s_waitcnt lgkmcnt(2)
    v_mfma_f32_32x32x16_bf16 v[144:159], v[112:115], v[128:131], v[144:159]
    s_waitcnt lgkmcnt(0)
    v_mfma_f32_32x32x16_bf16 v[144:159], v[116:119], v[132:135], v[144:159]
    ds_read_b128 v[32:35], v217 offset:0
    ds_read_b128 v[36:39], v217 offset:1024
    ds_read_b128 v[40:43], v217 offset:2048
    ds_read_b128 v[44:47], v217 offset:3072
    ds_read_b128 v[48:51], v217 offset:4096
    ds_read_b128 v[52:55], v217 offset:5120
    s_nop 5
    v_mov_b32 v13, v152
    v_mov_b32 v14, v152
    s_nop 1
    v_permlane32_swap_b32 v13, v14
    v_rcp_f32 v14, v14
    s_nop 0
    v_mov_b32 v15, v14
    v_pk_mul_f32 v[144:145], v[144:145], v[14:15]
    v_pk_mul_f32 v[146:147], v[146:147], v[14:15]
    v_pk_mul_f32 v[148:149], v[148:149], v[14:15]
    v_pk_mul_f32 v[150:151], v[150:151], v[14:15]
    v_pk_mul_f32 v[152:153], v[152:153], v[14:15]
    v_pk_mul_f32 v[154:155], v[154:155], v[14:15]
    v_cvt_pk_bf16_f32 v128, v144, v145
    v_cvt_pk_bf16_f32 v129, v146, v147
    v_cvt_pk_bf16_f32 v130, v148, v149
    v_cvt_pk_bf16_f32 v131, v150, v151
    v_cvt_pk_bf16_f32 v132, v152, v153
    v_cvt_pk_bf16_f32 v133, v154, v155
    buffer_store_dwordx4 v[128:131], v219, s[20:23], s68 offen sc1
    s_mov_b32 exec_hi, 0
    buffer_store_dwordx2 v[132:133], v220, s[20:23], s69 offen sc1
    s_mov_b32 exec_hi, -1
    s_waitcnt lgkmcnt(2)
    v_pk_add_f32 v[32:33], v[32:33], v[44:45]
    v_pk_add_f32 v[34:35], v[34:35], v[46:47]
    s_waitcnt lgkmcnt(1)
    v_pk_add_f32 v[36:37], v[36:37], v[48:49]
    v_pk_add_f32 v[38:39], v[38:39], v[50:51]
    s_waitcnt lgkmcnt(0)
    v_pk_add_f32 v[40:41], v[40:41], v[52:53]
    v_pk_add_f32 v[42:43], v[42:43], v[54:55]
    v_cvt_pk_bf16_f32 v136, v32, v33
    v_cvt_pk_bf16_f32 v137, v34, v35
    v_cvt_pk_bf16_f32 v138, v36, v37
    v_cvt_pk_bf16_f32 v139, v38, v39
    v_cvt_pk_bf16_f32 v140, v40, v41
    v_cvt_pk_bf16_f32 v141, v42, v43
    v_mov_b32 v142, 0
    v_mov_b32 v143, 0
    v_mfma_f32_32x32x16_bf16 v[160:175], v[136:139], v[208:211], 0
    s_nop 0
    v_mfma_f32_32x32x16_bf16 v[160:175], v[140:143], v[212:215], v[160:175]
    s_add_u32 s68, s68, 20480
    s_add_u32 s69, s69, 20480
    s_nop 9
    v_mov_b32 v13, v168
    v_mov_b32 v14, v168
    s_nop 1
    v_permlane32_swap_b32 v13, v14
    v_add_f32 v14, 0x358637bd, v14
    v_rcp_f32 v14, v14
    s_nop 0
    v_mov_b32 v15, v14
    v_pk_mul_f32 v[160:161], v[160:161], v[14:15]
    v_pk_mul_f32 v[162:163], v[162:163], v[14:15]
    v_pk_mul_f32 v[164:165], v[164:165], v[14:15]
    v_pk_mul_f32 v[166:167], v[166:167], v[14:15]
    v_pk_mul_f32 v[168:169], v[168:169], v[14:15]
    v_pk_mul_f32 v[170:171], v[170:171], v[14:15]
    v_cvt_pk_bf16_f32 v176, v160, v161
    v_cvt_pk_bf16_f32 v177, v162, v163
    v_cvt_pk_bf16_f32 v178, v164, v165
    v_cvt_pk_bf16_f32 v179, v166, v167
    v_cvt_pk_bf16_f32 v180, v168, v169
    v_cvt_pk_bf16_f32 v181, v170, v171
    buffer_store_dwordx4 v[176:179], v219, s[20:23], s68 offen sc1
    s_mov_b32 exec_hi, 0
    buffer_store_dwordx2 v[180:181], v220, s[20:23], s69 offen sc1
    s_mov_b32 exec_hi, -1
    s_mov_b32 s30, s29
    s_load_dwordx2 s[4:5], s[0:1], 56
    s_and_b32 s36, s2, 7
    s_lshr_b32 s37, s2, 3
    s_lshl_b32 s36, s36, 2
    s_lshr_b32 s17, s37, 3
    s_add_u32 s17, s17, s36
    s_and_b32 s18, s37, 7
    s_lshr_b32 s36, s33, 2
    s_mul_i32 s36, s36, 20480
    s_and_b32 s37, s33, 3
    s_lshl_b32 s19, s37, 10
    s_add_u32 s19, s19, s36
    s_add_u32 s19, s19, 16384
    s_lshl_b32 s37, s37, 12
    s_add_u32 s36, s36, s37
    v_and_b32 v15, 63, v0
    v_lshlrev_b32 v14, 4, v15
    v_add_u32 v10, s36, v14
    v_add_u32 v11, s19, v14
    s_mul_i32 s36, s17, 163840
    s_add_u32 s40, s36, 14680064
    s_add_u32 s41, s36, 14721024
    s_add_u32 s42, s36, 14761984
    s_add_u32 s43, s36, 14802944
    s_mul_i32 s36, s18, 204800
    s_add_u32 s44, s36, 19922944
    s_add_u32 s45, s36, 19963904
    s_add_u32 s46, s36, 20004864
    s_add_u32 s47, s36, 20045824
    s_add_u32 s48, s36, 20086784
    s_and_b32 s50, s2, 3
    s_lshl_b32 s50, s50, 6
    s_bfe_u32 s51, s2, 0x10002
    s_lshl_b32 s51, s51, 2
    s_add_u32 s50, s50, s51
    v_and_b32 v1, 7, v2
    v_lshlrev_b32 v1, 3, v1
    v_bfe_u32 v3, v2, 3, 2
    v_add3_u32 v1, v1, v3, s50
    v_lshlrev_b32 v237, 7, v1
    s_add_u32 s70, s70, 32768
    s_lshl_b32 s72, s2, 7
    s_add_u32 s72, s72, s70
    v_mov_b32 v232, s94
    v_mov_b32 v233, 0
    s_waitcnt lgkmcnt(0)
    s_mov_b32 s12, s4
    s_and_b32 s13, s5, 0xffff
    s_mov_b32 s14, 2621440
    s_mov_b32 s15, 0x20000
    s_waitcnt vmcnt(0)
    s_barrier
    s_cmp_lg_u32 s33, 0
    s_cbranch_scc1 S2_a
    s_mov_b32 exec_lo, 1
    s_mov_b32 exec_hi, 0
        buffer_store_dword v232, v233, s[20:23], s72 offen sc1
    s_mov_b32 exec_lo, -1
    s_mov_b32 exec_hi, -1
S2_a:
    v_add_u32 v1, s30, v14
    ds_read_b128 v[96:99], v1 offset:0
    ds_read_b128 v[100:103], v1 offset:1024
    ds_read_b128 v[104:107], v1 offset:2048
    ds_read_b128 v[108:111], v1 offset:3072
    ds_read_b128 v[112:115], v1 offset:4096
    ds_read_b128 v[116:119], v1 offset:5120
    ds_read_b128 v[120:123], v1 offset:6144
    ds_read_b128 v[124:127], v1 offset:7168
    ds_read_b128 v[128:131], v1 offset:8192
    ds_read_b128 v[132:135], v1 offset:9216
    ds_read_b128 v[136:139], v1 offset:10240
    buffer_load_dwordx4 v[140:143], v10, s[20:23], s45 offen offset:2048 sc1
    buffer_load_dwordx4 v[144:147], v10, s[20:23], s46 offen offset:2048 sc1
    buffer_load_dwordx4 v[148:151], v10, s[20:23], s47 offen offset:2048 sc1
    buffer_load_dwordx4 v[152:155], v10, s[20:23], s48 offen offset:2048 sc1
    buffer_load_dwordx4 v[156:159], v10, s[20:23], s44 offen offset:3072 sc1
    buffer_load_dwordx4 v[160:163], v10, s[20:23], s45 offen offset:3072 sc1
    buffer_load_dwordx4 v[164:167], v10, s[20:23], s46 offen offset:3072 sc1
    buffer_load_dwordx4 v[168:171], v10, s[20:23], s47 offen offset:3072 sc1
    buffer_load_dwordx4 v[172:175], v10, s[20:23], s48 offen offset:3072 sc1
    buffer_load_dwordx4 v[176:179], v11, s[20:23], s44 offen offset:0 sc1
    buffer_load_dwordx4 v[180:183], v11, s[20:23], s45 offen offset:0 sc1
    buffer_load_dwordx4 v[184:187], v11, s[20:23], s46 offen offset:0 sc1
    buffer_load_dwordx4 v[188:191], v11, s[20:23], s47 offen offset:0 sc1
    buffer_load_dwordx4 v[192:195], v11, s[20:23], s48 offen offset:0 sc1
    s_waitcnt lgkmcnt(0)
    s_cmp_lg_u32 s33, 0
    s_cbranch_scc1 S2_skip
    s_mov_b32 exec_lo, -1
    s_mov_b32 exec_hi, 0
    s_mov_b32 s95, 200000
POLL3:
        buffer_load_dword v232, v237, s[20:23], s70 offen sc1
        s_waitcnt vmcnt(0)
    v_xor_b32 v232, s94, v232
    v_cmp_ne_u32 vcc, 0, v232
    s_sub_u32 s95, s95, 1
    s_cmp_eq_u32 s95, 0
    s_cbranch_scc1 POLL3_out
    s_nop 2
    s_cbranch_vccz POLL3_out
    s_sleep 1
    s_branch POLL3
POLL3_out:
    s_mov_b32 exec_lo, -1
    s_mov_b32 exec_hi, -1
S2_skip:
    s_barrier
    v_lshrrev_b32 v2, 4, v15
    v_lshlrev_b32 v2, 8, v2
    v_and_b32 v1, 15, v15
    v_lshl_add_u32 v2, v1, 3, v2
    v_add_u32 v2, s19, v2
    buffer_load_dwordx4 v[196:199], v10, s[20:23], s40 offen offset:0 sc1
    buffer_load_dwordx4 v[200:203], v10, s[20:23], s41 offen offset:0 sc1
    buffer_load_dwordx4 v[204:207], v10, s[20:23], s42 offen offset:0 sc1
    buffer_load_dwordx4 v[208:211], v10, s[20:23], s43 offen offset:0 sc1
    buffer_load_dwordx4 v[212:215], v10, s[20:23], s40 offen offset:1024 sc1
    buffer_load_dwordx4 v[216:219], v10, s[20:23], s41 offen offset:1024 sc1
    buffer_load_dwordx4 v[220:223], v10, s[20:23], s42 offen offset:1024 sc1
    buffer_load_dwordx4 v[224:227], v10, s[20:23], s43 offen offset:1024 sc1
    s_mul_i32 s36, s33, 20480
    v_add_u32 v1, s36, v14
    s_waitcnt vmcnt(7)
    v_mfma_f32_16x16x32_bf16 v[16:19], v[96:99], v[196:199], 0
    buffer_load_dwordx4 v[228:231], v10, s[20:23], s40 offen offset:2048 sc1
    v_mfma_f32_16x16x32_bf16 v[32:35], v[100:103], v[196:199], 0
    v_mfma_f32_16x16x32_bf16 v[48:51], v[104:107], v[196:199], 0
    buffer_load_dwordx4 v[232:235], v10, s[20:23], s41 offen offset:2048 sc1
    v_mfma_f32_16x16x32_bf16 v[64:67], v[108:111], v[196:199], 0
    v_mfma_f32_16x16x32_bf16 v[80:83], v[112:115], v[196:199], 0
    buffer_load_dwordx4 v[236:239], v10, s[20:23], s42 offen offset:2048 sc1
    s_waitcnt vmcnt(9)
    v_mfma_f32_16x16x32_bf16 v[20:23], v[96:99], v[200:203], 0
    v_mfma_f32_16x16x32_bf16 v[36:39], v[100:103], v[200:203], 0
    buffer_load_dwordx4 v[240:243], v10, s[20:23], s43 offen offset:2048 sc1
    v_mfma_f32_16x16x32_bf16 v[52:55], v[104:107], v[200:203], 0
    v_mfma_f32_16x16x32_bf16 v[68:71], v[108:111], v[200:203], 0
    v_mfma_f32_16x16x32_bf16 v[84:87], v[112:115], v[200:203], 0
    s_waitcnt vmcnt(9)
    v_mfma_f32_16x16x32_bf16 v[24:27], v[96:99], v[204:207], 0
    v_mfma_f32_16x16x32_bf16 v[40:43], v[100:103], v[204:207], 0
    v_mfma_f32_16x16x32_bf16 v[56:59], v[104:107], v[204:207], 0
    v_mfma_f32_16x16x32_bf16 v[72:75], v[108:111], v[204:207], 0
    v_mfma_f32_16x16x32_bf16 v[88:91], v[112:115], v[204:207], 0
    s_waitcnt vmcnt(8)
    v_mfma_f32_16x16x32_bf16 v[28:31], v[96:99], v[208:211], 0
    v_mfma_f32_16x16x32_bf16 v[44:47], v[100:103], v[208:211], 0
    v_mfma_f32_16x16x32_bf16 v[60:63], v[104:107], v[208:211], 0
    v_mfma_f32_16x16x32_bf16 v[76:79], v[108:111], v[208:211], 0
    v_mfma_f32_16x16x32_bf16 v[92:95], v[112:115], v[208:211], 0
    s_waitcnt vmcnt(7)
    v_mfma_f32_16x16x32_bf16 v[16:19], v[116:119], v[212:215], v[16:19]
    buffer_load_dwordx4 v[96:99], v10, s[20:23], s40 offen offset:3072 sc1
    v_mfma_f32_16x16x32_bf16 v[32:35], v[120:123], v[212:215], v[32:35]
    v_mfma_f32_16x16x32_bf16 v[48:51], v[124:127], v[212:215], v[48:51]
    buffer_load_dwordx4 v[100:103], v10, s[20:23], s41 offen offset:3072 sc1
    v_mfma_f32_16x16x32_bf16 v[64:67], v[128:131], v[212:215], v[64:67]
    v_mfma_f32_16x16x32_bf16 v[80:83], v[132:135], v[212:215], v[80:83]
    buffer_load_dwordx4 v[104:107], v10, s[20:23], s42 offen offset:3072 sc1
    s_waitcnt vmcnt(9)
    v_mfma_f32_16x16x32_bf16 v[20:23], v[116:119], v[216:219], v[20:23]
    v_mfma_f32_16x16x32_bf16 v[36:39], v[120:123], v[216:219], v[36:39]
    buffer_load_dwordx4 v[108:111], v10, s[20:23], s43 offen offset:3072 sc1
    v_mfma_f32_16x16x32_bf16 v[52:55], v[124:127], v[216:219], v[52:55]
    v_mfma_f32_16x16x32_bf16 v[68:71], v[128:131], v[216:219], v[68:71]
    v_mfma_f32_16x16x32_bf16 v[84:87], v[132:135], v[216:219], v[84:87]
    s_waitcnt vmcnt(9)
    v_mfma_f32_16x16x32_bf16 v[24:27], v[116:119], v[220:223], v[24:27]
    v_mfma_f32_16x16x32_bf16 v[40:43], v[120:123], v[220:223], v[40:43]
    v_mfma_f32_16x16x32_bf16 v[56:59], v[124:127], v[220:223], v[56:59]
    v_mfma_f32_16x16x32_bf16 v[72:75], v[128:131], v[220:223], v[72:75]
    v_mfma_f32_16x16x32_bf16 v[88:91], v[132:135], v[220:223], v[88:91]
    s_waitcnt vmcnt(8)
    v_mfma_f32_16x16x32_bf16 v[28:31], v[116:119], v[224:227], v[28:31]
    v_mfma_f32_16x16x32_bf16 v[44:47], v[120:123], v[224:227], v[44:47]
    v_mfma_f32_16x16x32_bf16 v[60:63], v[124:127], v[224:227], v[60:63]
    v_mfma_f32_16x16x32_bf16 v[76:79], v[128:131], v[224:227], v[76:79]
    v_mfma_f32_16x16x32_bf16 v[92:95], v[132:135], v[224:227], v[92:95]
    s_waitcnt vmcnt(7)
    v_mfma_f32_16x16x32_bf16 v[16:19], v[136:139], v[228:231], v[16:19]
    buffer_load_dwordx2 v[116:117], v2, s[20:23], s40 offen sc1
    buffer_load_dwordx2 v[118:119], v2, s[20:23], s40 offen offset:128 sc1
    v_mfma_f32_16x16x32_bf16 v[32:35], v[140:143], v[228:231], v[32:35]
    v_mfma_f32_16x16x32_bf16 v[48:51], v[144:147], v[228:231], v[48:51]
    buffer_load_dwordx2 v[120:121], v2, s[20:23], s41 offen sc1
    buffer_load_dwordx2 v[122:123], v2, s[20:23], s41 offen offset:128 sc1
    v_mfma_f32_16x16x32_bf16 v[64:67], v[148:151], v[228:231], v[64:67]
    v_mfma_f32_16x16x32_bf16 v[80:83], v[152:155], v[228:231], v[80:83]
    buffer_load_dwordx2 v[124:125], v2, s[20:23], s42 offen sc1
    buffer_load_dwordx2 v[126:127], v2, s[20:23], s42 offen offset:128 sc1
    s_waitcnt vmcnt(12)
    v_mfma_f32_16x16x32_bf16 v[20:23], v[136:139], v[232:235], v[20:23]
    v_mfma_f32_16x16x32_bf16 v[36:39], v[140:143], v[232:235], v[36:39]
    buffer_load_dwordx2 v[128:129], v2, s[20:23], s43 offen sc1
    buffer_load_dwordx2 v[130:131], v2, s[20:23], s43 offen offset:128 sc1
    v_mfma_f32_16x16x32_bf16 v[52:55], v[144:147], v[232:235], v[52:55]
    v_mfma_f32_16x16x32_bf16 v[68:71], v[148:151], v[232:235], v[68:71]
    v_mfma_f32_16x16x32_bf16 v[84:87], v[152:155], v[232:235], v[84:87]
    s_waitcnt vmcnt(13)
    v_mfma_f32_16x16x32_bf16 v[24:27], v[136:139], v[236:239], v[24:27]
    v_mfma_f32_16x16x32_bf16 v[40:43], v[140:143], v[236:239], v[40:43]
    v_mfma_f32_16x16x32_bf16 v[56:59], v[144:147], v[236:239], v[56:59]
    v_mfma_f32_16x16x32_bf16 v[72:75], v[148:151], v[236:239], v[72:75]
    v_mfma_f32_16x16x32_bf16 v[88:91], v[152:155], v[236:239], v[88:91]
    s_waitcnt vmcnt(12)
    v_mfma_f32_16x16x32_bf16 v[28:31], v[136:139], v[240:243], v[28:31]
    v_mfma_f32_16x16x32_bf16 v[44:47], v[140:143], v[240:243], v[44:47]
    v_mfma_f32_16x16x32_bf16 v[60:63], v[144:147], v[240:243], v[60:63]
    v_mfma_f32_16x16x32_bf16 v[76:79], v[148:151], v[240:243], v[76:79]
    v_mfma_f32_16x16x32_bf16 v[92:95], v[152:155], v[240:243], v[92:95]
    s_mul_i32 s36, s33, 3
    s_lshl_b32 s37, s33, 1
    s_add_u32 s37, s37, 4
    s_cmp_lt_u32 s33, 4
    s_cselect_b32 s38, s36, s37
    v_and_b32 v12, 15, v15
    v_lshlrev_b32 v13, 3, v12
    s_add_u32 s36, s38, 0
    s_and_b32 s36, s36, 3
    s_lshl_b32 s36, s36, 7
    s_lshl_b32 s37, s17, 9
    s_add_u32 s36, s36, s37
    s_add_u32 s36, s36, 22020096
    buffer_load_dwordx2 v[4:5], v13, s[20:23], s36 offen sc1
    s_add_u32 s36, s38, 1
    s_and_b32 s36, s36, 3
    s_lshl_b32 s36, s36, 7
    s_lshl_b32 s37, s17, 9
    s_add_u32 s36, s36, s37
    s_add_u32 s36, s36, 22020096
    buffer_load_dwordx2 v[6:7], v13, s[20:23], s36 offen sc1
    s_add_u32 s36, s38, 2
    s_and_b32 s36, s36, 3
    s_lshl_b32 s36, s36, 7
    s_lshl_b32 s37, s17, 9
    s_add_u32 s36, s36, s37
    s_add_u32 s36, s36, 22020096
    buffer_load_dwordx2 v[8:9], v13, s[20:23], s36 offen sc1
    s_waitcnt vmcnt(14)
    v_mfma_f32_16x16x32_bf16 v[16:19], v[156:159], v[96:99], v[16:19]
    v_mfma_f32_16x16x32_bf16 v[32:35], v[160:163], v[96:99], v[32:35]
    v_mfma_f32_16x16x32_bf16 v[48:51], v[164:167], v[96:99], v[48:51]
    v_mfma_f32_16x16x32_bf16 v[64:67], v[168:171], v[96:99], v[64:67]
    v_mfma_f32_16x16x32_bf16 v[80:83], v[172:175], v[96:99], v[80:83]
    s_waitcnt vmcnt(13)
    v_mfma_f32_16x16x32_bf16 v[20:23], v[156:159], v[100:103], v[20:23]
    v_mfma_f32_16x16x32_bf16 v[36:39], v[160:163], v[100:103], v[36:39]
    v_mfma_f32_16x16x32_bf16 v[52:55], v[164:167], v[100:103], v[52:55]
    v_mfma_f32_16x16x32_bf16 v[68:71], v[168:171], v[100:103], v[68:71]
    v_mfma_f32_16x16x32_bf16 v[84:87], v[172:175], v[100:103], v[84:87]
    s_waitcnt vmcnt(12)
    v_mfma_f32_16x16x32_bf16 v[24:27], v[156:159], v[104:107], v[24:27]
    v_mfma_f32_16x16x32_bf16 v[40:43], v[160:163], v[104:107], v[40:43]
    v_mfma_f32_16x16x32_bf16 v[56:59], v[164:167], v[104:107], v[56:59]
    v_mfma_f32_16x16x32_bf16 v[72:75], v[168:171], v[104:107], v[72:75]
    v_mfma_f32_16x16x32_bf16 v[88:91], v[172:175], v[104:107], v[88:91]
    s_waitcnt vmcnt(11)
    v_mfma_f32_16x16x32_bf16 v[28:31], v[156:159], v[108:111], v[28:31]
    v_mfma_f32_16x16x32_bf16 v[44:47], v[160:163], v[108:111], v[44:47]
    v_mfma_f32_16x16x32_bf16 v[60:63], v[164:167], v[108:111], v[60:63]
    v_mfma_f32_16x16x32_bf16 v[76:79], v[168:171], v[108:111], v[76:79]
    v_mfma_f32_16x16x32_bf16 v[92:95], v[172:175], v[108:111], v[92:95]
    s_waitcnt vmcnt(9)
    v_mfma_f32_16x16x32_bf16 v[16:19], v[176:179], v[116:119], v[16:19]
    v_mfma_f32_16x16x32_bf16 v[32:35], v[180:183], v[116:119], v[32:35]
    v_mfma_f32_16x16x32_bf16 v[48:51], v[184:187], v[116:119], v[48:51]
    v_mfma_f32_16x16x32_bf16 v[64:67], v[188:191], v[116:119], v[64:67]
    v_mfma_f32_16x16x32_bf16 v[80:83], v[192:195], v[116:119], v[80:83]
    s_waitcnt vmcnt(7)
    v_mfma_f32_16x16x32_bf16 v[20:23], v[176:179], v[120:123], v[20:23]
    v_mfma_f32_16x16x32_bf16 v[36:39], v[180:183], v[120:123], v[36:39]
    v_mfma_f32_16x16x32_bf16 v[52:55], v[184:187], v[120:123], v[52:55]
    v_mfma_f32_16x16x32_bf16 v[68:71], v[188:191], v[120:123], v[68:71]
    ds_write_b128 v1, v[16:19] offset:0
    v_mfma_f32_16x16x32_bf16 v[84:87], v[192:195], v[120:123], v[84:87]
    ds_write_b128 v1, v[32:35] offset:4096
    s_waitcnt vmcnt(5)
    v_mfma_f32_16x16x32_bf16 v[24:27], v[176:179], v[124:127], v[24:27]
    ds_write_b128 v1, v[48:51] offset:8192
    v_mfma_f32_16x16x32_bf16 v[40:43], v[180:183], v[124:127], v[40:43]
    ds_write_b128 v1, v[64:67] offset:12288
    v_mfma_f32_16x16x32_bf16 v[56:59], v[184:187], v[124:127], v[56:59]
    ds_write_b128 v1, v[80:83] offset:16384
    v_mfma_f32_16x16x32_bf16 v[72:75], v[188:191], v[124:127], v[72:75]
    ds_write_b128 v1, v[20:23] offset:1024
    v_mfma_f32_16x16x32_bf16 v[88:91], v[192:195], v[124:127], v[88:91]
    ds_write_b128 v1, v[36:39] offset:5120
    s_waitcnt vmcnt(3)
    v_mfma_f32_16x16x32_bf16 v[28:31], v[176:179], v[128:131], v[28:31]
    ds_write_b128 v1, v[52:55] offset:9216
    v_mfma_f32_16x16x32_bf16 v[44:47], v[180:183], v[128:131], v[44:47]
    ds_write_b128 v1, v[68:71] offset:13312
    v_mfma_f32_16x16x32_bf16 v[60:63], v[184:187], v[128:131], v[60:63]
    ds_write_b128 v1, v[84:87] offset:17408
    v_mfma_f32_16x16x32_bf16 v[76:79], v[188:191], v[128:131], v[76:79]
    ds_write_b128 v1, v[24:27] offset:2048
    v_mfma_f32_16x16x32_bf16 v[92:95], v[192:195], v[128:131], v[92:95]
    ds_write_b128 v1, v[40:43] offset:6144
    ds_write_b128 v1, v[56:59] offset:10240
    ds_write_b128 v1, v[72:75] offset:14336
    ds_write_b128 v1, v[88:91] offset:18432
    ds_write_b128 v1, v[28:31] offset:3072
    ds_write_b128 v1, v[44:47] offset:7168
    ds_write_b128 v1, v[60:63] offset:11264
    ds_write_b128 v1, v[76:79] offset:15360
    ds_write_b128 v1, v[92:95] offset:19456
    s_lshl_b32 s36, s38, 10
    v_add_u32 v10, s36, v14
    v_add_u32 v11, 61440, v10
    v_add_u32 v13, 122880, v10
    v_lshrrev_b32 v14, 4, v15
    v_lshlrev_b32 v14, 3, v14
    s_movk_i32 s36, 1280
    v_mad_u32_u24 v14, v12, s36, v14
    s_mul_i32 s39, s17, 81920
    s_mul_i32 s37, s18, 160
    s_add_u32 s39, s39, s37
    s_waitcnt lgkmcnt(0)
    s_barrier
    ds_read_b128 v[96:99], v10 offset:0
    ds_read_b128 v[100:103], v10 offset:20480
    ds_read_b128 v[104:107], v10 offset:40960
    ds_read_b128 v[108:111], v11 offset:0
    ds_read_b128 v[112:115], v11 offset:20480
    ds_read_b128 v[116:119], v11 offset:40960
    ds_read_b128 v[120:123], v13 offset:0
    ds_read_b128 v[124:127], v13 offset:20480
    ds_read_b128 v[128:131], v10 offset:1024
    ds_read_b128 v[132:135], v10 offset:21504
    ds_read_b128 v[136:139], v10 offset:41984
    ds_read_b128 v[140:143], v11 offset:1024
    ds_read_b128 v[144:147], v11 offset:21504
    ds_read_b128 v[148:151], v11 offset:41984
    ds_read_b128 v[152:155], v13 offset:1024
    ds_read_b128 v[156:159], v13 offset:21504
    ds_read_b128 v[160:163], v10 offset:2048
    ds_read_b128 v[164:167], v10 offset:22528
    ds_read_b128 v[168:171], v10 offset:43008
    ds_read_b128 v[172:175], v11 offset:2048
    ds_read_b128 v[176:179], v11 offset:22528
    ds_read_b128 v[180:183], v11 offset:43008
    ds_read_b128 v[184:187], v13 offset:2048
    ds_read_b128 v[188:191], v13 offset:22528
    s_waitcnt lgkmcnt(15)
    v_pk_add_f32 v[96:97], v[96:97], v[100:101]
    s_waitcnt lgkmcnt(15)
    v_pk_add_f32 v[104:105], v[104:105], v[108:109]
    s_waitcnt lgkmcnt(15)
    v_pk_add_f32 v[112:113], v[112:113], v[116:117]
    s_waitcnt lgkmcnt(15)
    v_pk_add_f32 v[120:121], v[120:121], v[124:125]
    v_pk_add_f32 v[98:99], v[98:99], v[102:103]
    v_pk_add_f32 v[106:107], v[106:107], v[110:111]
    v_pk_add_f32 v[114:115], v[114:115], v[118:119]
    v_pk_add_f32 v[122:123], v[122:123], v[126:127]
    v_pk_add_f32 v[96:97], v[96:97], v[104:105]
    v_pk_add_f32 v[112:113], v[112:113], v[120:121]
    v_pk_add_f32 v[98:99], v[98:99], v[106:107]
    v_pk_add_f32 v[114:115], v[114:115], v[122:123]
    s_waitcnt vmcnt(2)
    v_mul_f32 v96, v4, v96
    v_mul_f32 v97, v4, v97
    v_mul_f32 v98, v4, v98
    v_mul_f32 v99, v4, v99
    v_fmac_f32 v96, v5, v112
    v_fmac_f32 v97, v5, v113
    v_fmac_f32 v98, v5, v114
    v_fmac_f32 v99, v5, v115
    v_cvt_pk_bf16_f32 v100, v96, v97
    v_cvt_pk_bf16_f32 v101, v98, v99
    s_add_u32 s36, s38, 0
    s_and_b32 s37, s36, 3
    s_mul_i32 s37, s37, 20480
    s_lshr_b32 s36, s36, 2
    s_lshl_b32 s36, s36, 5
    s_add_u32 s36, s36, s37
    s_add_u32 s36, s36, s39
    buffer_store_dwordx2 v[100:101], v14, s[12:15], s36 offen
    s_waitcnt lgkmcnt(14)
    v_pk_add_f32 v[128:129], v[128:129], v[132:133]
    s_waitcnt lgkmcnt(12)
    v_pk_add_f32 v[136:137], v[136:137], v[140:141]
    s_waitcnt lgkmcnt(10)
    v_pk_add_f32 v[144:145], v[144:145], v[148:149]
    s_waitcnt lgkmcnt(8)
    v_pk_add_f32 v[152:153], v[152:153], v[156:157]
    v_pk_add_f32 v[130:131], v[130:131], v[134:135]
    v_pk_add_f32 v[138:139], v[138:139], v[142:143]
    v_pk_add_f32 v[146:147], v[146:147], v[150:151]
    v_pk_add_f32 v[154:155], v[154:155], v[158:159]
    v_pk_add_f32 v[128:129], v[128:129], v[136:137]
    v_pk_add_f32 v[144:145], v[144:145], v[152:153]
    v_pk_add_f32 v[130:131], v[130:131], v[138:139]
    v_pk_add_f32 v[146:147], v[146:147], v[154:155]
    s_waitcnt vmcnt(2)
    v_mul_f32 v128, v6, v128
    v_mul_f32 v129, v6, v129
    v_mul_f32 v130, v6, v130
    v_mul_f32 v131, v6, v131
    v_fmac_f32 v128, v7, v144
    v_fmac_f32 v129, v7, v145
    v_fmac_f32 v130, v7, v146
    v_fmac_f32 v131, v7, v147
    v_cvt_pk_bf16_f32 v132, v128, v129
    v_cvt_pk_bf16_f32 v133, v130, v131
    s_add_u32 s36, s38, 1
    s_and_b32 s37, s36, 3
    s_mul_i32 s37, s37, 20480
    s_lshr_b32 s36, s36, 2
    s_lshl_b32 s36, s36, 5
    s_add_u32 s36, s36, s37
    s_add_u32 s36, s36, s39
    buffer_store_dwordx2 v[132:133], v14, s[12:15], s36 offen
    s_cmp_lt_u32 s33, 4
    s_cbranch_scc0 P3_done
    s_waitcnt lgkmcnt(6)
    v_pk_add_f32 v[160:161], v[160:161], v[164:165]
    s_waitcnt lgkmcnt(4)
    v_pk_add_f32 v[168:169], v[168:169], v[172:173]
    s_waitcnt lgkmcnt(2)
    v_pk_add_f32 v[176:177], v[176:177], v[180:181]
    s_waitcnt lgkmcnt(0)
    v_pk_add_f32 v[184:185], v[184:185], v[188:189]
    v_pk_add_f32 v[162:163], v[162:163], v[166:167]
    v_pk_add_f32 v[170:171], v[170:171], v[174:175]
    v_pk_add_f32 v[178:179], v[178:179], v[182:183]
    v_pk_add_f32 v[186:187], v[186:187], v[190:191]
    v_pk_add_f32 v[160:161], v[160:161], v[168:169]
    v_pk_add_f32 v[176:177], v[176:177], v[184:185]
    v_pk_add_f32 v[162:163], v[162:163], v[170:171]
    v_pk_add_f32 v[178:179], v[178:179], v[186:187]
    s_waitcnt vmcnt(2)
    v_mul_f32 v160, v8, v160
    v_mul_f32 v161, v8, v161
    v_mul_f32 v162, v8, v162
    v_mul_f32 v163, v8, v163
    v_fmac_f32 v160, v9, v176
    v_fmac_f32 v161, v9, v177
    v_fmac_f32 v162, v9, v178
    v_fmac_f32 v163, v9, v179
    v_cvt_pk_bf16_f32 v164, v160, v161
    v_cvt_pk_bf16_f32 v165, v162, v163
    s_add_u32 s36, s38, 2
    s_and_b32 s37, s36, 3
    s_mul_i32 s37, s37, 20480
    s_lshr_b32 s36, s36, 2
    s_lshl_b32 s36, s36, 5
    s_add_u32 s36, s36, s37
    s_add_u32 s36, s36, s39
    buffer_store_dwordx2 v[164:165], v14, s[12:15], s36 offen
P3_done:
K1_end:
    s_endpgm
CODE_END:
.section .rodata,"a"
.p2align 6
.amdhsa_kernel gated_mix__sliding_block__linear_attn_block__prompt_kernel
  .amdhsa_next_free_vgpr 256
  .amdhsa_next_free_sgpr 100
  .amdhsa_accum_offset 256
  .amdhsa_group_segment_fixed_size 0
  .amdhsa_kernarg_size 80
  .amdhsa_user_sgpr_count 2
  .amdhsa_user_sgpr_kernarg_segment_ptr 1
  .amdhsa_system_sgpr_workgroup_id_x 1
.end_amdhsa_kernel
```
